```python
import torch

def _softmax(x, axis=-1):
    return torch.softmax(x, dim=axis)

def _gelu(x):
    return torch.nn.functional.gelu(x, approximate='tanh')

def _silu(x):
    return torch.nn.functional.silu(x)

def _sigmoid(x):
    return torch.sigmoid(x)

def _layernorm(x, axis=-1, eps=1e-05):
    m = x.mean(dim=axis, keepdim=True)
    v = x.var(dim=axis, keepdim=True, unbiased=False)
    return (x - m) / torch.sqrt(v + eps)

def _scatter_add(tgt, idx, src, axis=0):
    return tgt.clone().index_add_(axis, idx, src)

def _segment_sum(src, seg, n):
    out = torch.zeros((n,) + src.shape[1:], dtype=src.dtype)
    return out.index_add_(0, seg, src)

def _pad(x, pw):
    flat = tuple((v for pair in reversed(pw) for v in pair))
    return torch.nn.functional.pad(x, flat)
kernel_name = 'adaLN_cond__sliding_block_cached__swiglu_ffn__decode'

def setup_inputs():

    _w = lambda a: (lambda t: t.to(torch.bfloat16) if t.is_floating_point() else t)(torch.as_tensor(a))

    def _A_setup():
        B, Sq, D = (8, 1, 1024)
        Hq, Hkv, Sk, Dh = (32, 4, 4096, 128)
        assert Hq % Hkv == 0, (Hq, Hkv)
        return {'x': _w((lambda *s: torch.randn(*s, dtype=torch.bfloat16) * 0.05)(B, Sq, D)), 'k_cache': _w((lambda *s: torch.randn(*s, dtype=torch.bfloat16) * 3.2)(B, Hkv, Sk, Dh)), 'v_cache': _w((lambda *s: torch.randn(*s, dtype=torch.bfloat16) * 0.4)(B, Hkv, Sk, Dh)), 'wq': _w((lambda *s: torch.randn(*s, dtype=torch.bfloat16) * 3.2)(D, Hq * Dh) * D ** (-0.5)), 'wo': _w((lambda *s: torch.randn(*s, dtype=torch.bfloat16) * 0.4)(Hq * Dh, D) * (Hq * Dh) ** (-0.5))}
    _A_in = _A_setup()

    def _B_setup():
        B, S, D, F = (8, 1, 1024, 3584)
        return {'x': _w((lambda *s: torch.randn(*s, dtype=torch.bfloat16) * 0.05)(B, S, D)), 'w_gate': _w((lambda *s: torch.randn(*s, dtype=torch.bfloat16) * 0.05)(D, F)), 'w_up': _w((lambda *s: torch.randn(*s, dtype=torch.bfloat16) * 0.05)(D, F)), 'w_down': _w((lambda *s: torch.randn(*s, dtype=torch.bfloat16) * 0.05)(F, D))}
    _B_in = _B_setup()
    return {'A_x': _A_in['x'], 'A_k_cache': _A_in['k_cache'], 'A_v_cache': _A_in['v_cache'], 'A_wq': _A_in['wq'], 'A_wo': _A_in['wo'], 'B_x': _B_in['x'], 'B_w_gate': _B_in['w_gate'], 'B_w_up': _B_in['w_up'], 'B_w_down': _B_in['w_down'], 'c': _w((lambda *s: torch.randn(*s, dtype=torch.bfloat16) * 0.1)(8, 1024) * 8.0), 'w_mod': _w((lambda *s: torch.randn(*s, dtype=torch.bfloat16) * 0.1)(1024, 6 * 1024) * 1024 ** (-0.5) * 8.0)}

def reference(A_x, A_k_cache, A_v_cache, A_wq, A_wo, B_x, B_w_gate, B_w_up, B_w_down, c, w_mod):

    def _A_ref(x, k_cache, v_cache, wq, wo):
        B, Sq, D = x.shape
        Hq, Dh = (32, 128)
        Hkv, Sk = (k_cache.shape[1], k_cache.shape[2])
        W = min(4096, max(256, Sk // 4))
        rep = Hq // Hkv
        q = (lambda x, *d: x.permute(*d))((x @ wq).reshape(B, Sq, Hq, Dh), 0, 2, 1, 3)
        k = (lambda x, n, axis: torch.repeat_interleave(x, n, dim=axis))(k_cache[:, :, Sk - W:, :], rep, axis=1)
        v = (lambda x, n, axis: torch.repeat_interleave(x, n, dim=axis))(v_cache[:, :, Sk - W:, :], rep, axis=1)
        scores = torch.einsum('bhqd,bhkd->bhqk', q, k) * Dh ** (-0.5)
        p = _softmax(scores, axis=-1)
        o = torch.einsum('bhqk,bhkd->bhqd', p, v)
        return (lambda x, *d: x.permute(*d))(o, 0, 2, 1, 3).reshape(B, Sq, Hq * Dh) @ wo

    def _B_ref(x, w_gate, w_up, w_down):
        g = _silu(x @ w_gate)
        u = x @ w_up
        return g * u @ w_down
    x = A_x
    mod = (_silu(c) @ w_mod).reshape(c.shape[0], 6, 1, -1)
    sa, ca, ga, sb, cb, gb = (mod[:, 0].clone(), mod[:, 1].clone(), mod[:, 2].clone(), mod[:, 3].clone(), mod[:, 4].clone(), mod[:, 5].clone())
    h = _layernorm(x, axis=-1) * (1 + ca) + sa
    x = x + ga * _A_ref(h, A_k_cache, A_v_cache, A_wq, A_wo)
    h = _layernorm(x, axis=-1) * (1 + cb) + sb
    x = x + gb * _B_ref(h, B_w_gate, B_w_up, B_w_down)
    return x
```

```asm
; @launch grid=(256,1,1) block=(576,1,1) lds=143360
.amdgcn_target "amdgcn-amd-amdhsa--gfx950"
.text
.globl adaLN_cond__sliding_block_cached__swiglu_ffn__decode_kernel
.p2align 8
.type adaLN_cond__sliding_block_cached__swiglu_ffn__decode_kernel,@function
adaLN_cond__sliding_block_cached__swiglu_ffn__decode_kernel:
    s_cmp_ge_u32 s2, 256
    s_cbranch_scc1 L_exit
    s_getpc_b64 s[66:67]
L_pc:
    s_bfe_u32 s68, s2, 0x20003
    s_lshl_b32 s68, s68, 7
    v_subrev_u32 v8, 0, v0
    v_cmp_gt_u32 vcc, 64, v8
    s_cbranch_vccz L_npre
    v_lshl_add_u32 v8, v8, 9, s68
    v_min_u32 v8, L_exit-L_pc, v8
    global_load_dword v40, v8, s[66:67]
L_npre:
    s_load_dwordx2 s[44:45], s[0:1], 80
    s_load_dwordx2 s[20:21], s[0:1], 24
    s_load_dwordx2 s[12:13], s[0:1], 8
    s_load_dwordx2 s[40:41], s[0:1], 72
    s_load_dwordx2 s[8:9], s[0:1], 0
    s_load_dwordx2 s[52:53], s[0:1], 104
    s_load_dwordx2 s[16:17], s[0:1], 16
    s_load_dwordx2 s[24:25], s[0:1], 32
    s_load_dwordx2 s[28:29], s[0:1], 48
    s_load_dwordx2 s[32:33], s[0:1], 56
    s_load_dwordx2 s[36:37], s[0:1], 64
    s_load_dwordx2 s[48:49], s[0:1], 88
    s_mov_b32 s46, 12582912
    s_mov_b32 s47, 0x20000
    s_mov_b32 s22, 8388608
    s_mov_b32 s23, 0x20000
    s_mov_b32 s14, 33554432
    s_mov_b32 s15, 0x20000
    s_mov_b32 s42, 16384
    s_mov_b32 s43, 0x20000
    s_mov_b32 s10, 16384
    s_mov_b32 s11, 0x20000
    s_mov_b32 s54, 9437184
    s_mov_b32 s55, 0x20000
    s_mov_b32 s18, 33554432
    s_mov_b32 s19, 0x20000
    s_mov_b32 s26, 8388608
    s_mov_b32 s27, 0x20000
    s_mov_b32 s30, 7340032
    s_mov_b32 s31, 0x20000
    s_mov_b32 s34, 7340032
    s_mov_b32 s35, 0x20000
    s_mov_b32 s38, 7340032
    s_mov_b32 s39, 0x20000
    s_mov_b32 s50, 16384
    s_mov_b32 s51, 0x20000
    v_and_b32 v1, 63, v0
    v_lshrrev_b32 v7, 6, v0
    v_lshrrev_b32 v2, 4, v1
    v_readfirstlane_b32 s3, v7
    v_and_b32 v3, 15, v0
    v_and_b32 v4, 7, v0
    v_bfe_u32 v5, v0, 3, 1
    v_mov_b32 v7, 0
    v_mov_b32 v14, 0x20000
    s_and_b32 s5, s2, 7
    s_lshr_b32 s6, s2, 3
    s_lshr_b32 s65, s5, 1
    s_xor_b32 s65, s65, 1
    s_cmp_lt_u32 s3, 8
    s_cbranch_scc1 L_compute
    s_setprio 3
    s_mov_b32 s93, 0
    v_lshrrev_b32 v8, 3, v1
    v_lshlrev_b32 v9, 1, v2
    v_xor_b32 v9, v9, v4
    v_lshlrev_b32 v9, 4, v9
    s_and_b32 s67, s6, 3
    s_mul_i32 s66, s67, 3145728
    s_lshr_b32 s67, s6, 3
    s_lshl_b32 s67, s67, 11
    s_add_u32 s66, s66, s67
    s_lshl_b32 s67, s5, 8
    s_add_u32 s66, s66, s67
    s_bfe_u32 s67, s6, 0x10002
    s_lshl_b32 s67, s67, 7
    s_add_u32 s66, s66, s67
    s_lshl_b32 s70, s5, 11
    s_add_u32 s70, s70, s6
    s_sub_u32 s70, s70, 16
    s_lshl_b32 s70, s70, 9
    s_cmp_ge_u32 s6, 16
    s_cselect_b32 s66, s70, s66
    s_cselect_b32 s70, 2, 3
    s_cselect_b32 s71, 1, 6144
    s_cselect_b32 s77, -2, -1
    s_cselect_b32 s62, s22, s46
    s_mov_b32 s63, 0x20000
    s_lshl_b32 s71, s71, 7
    s_lshl_b32 s70, s70, 12
    v_mad_u32_u24 v24, v8, s70, v9
    s_lshl_b32 s67, s70, 5
    v_add_u32 v28, s67, v24
    s_lshl_b32 s67, s70, 3
    s_sub_u32 s67, s67, 1024
    v_add_u32 v25, s67, v24
    v_add_u32 v26, s67, v25
    v_add_u32 v27, s67, v26
    v_add_u32 v29, s67, v28
    v_add_u32 v30, s67, v29
    v_add_u32 v31, s67, v30
    s_mov_b32 s73, 0
    s_mov_b32 s75, -4
    s_cmp_ge_u32 s6, 16
    s_waitcnt lgkmcnt(0)
    s_cselect_b32 s60, s20, s44
    s_cselect_b32 s61, s21, s45
L_l0:
    s_mov_b32 m0, s73
    s_waitcnt vmcnt(52)
    buffer_load_dwordx4 v24, s[60:63], s66 offen offset:0 nt lds
    buffer_load_dwordx4 v25, s[60:63], s66 offen offset:1024 nt lds
    buffer_load_dwordx4 v26, s[60:63], s66 offen offset:2048 nt lds
    buffer_load_dwordx4 v27, s[60:63], s66 offen offset:3072 nt lds
    s_add_u32 m0, s73, 4096
    s_waitcnt vmcnt(52)
    buffer_load_dwordx4 v28, s[60:63], s66 offen offset:0 nt lds
    buffer_load_dwordx4 v29, s[60:63], s66 offen offset:1024 nt lds
    buffer_load_dwordx4 v30, s[60:63], s66 offen offset:2048 nt lds
    buffer_load_dwordx4 v31, s[60:63], s66 offen offset:3072 nt lds
    s_add_u32 s73, s73, 8192
    s_add_u32 s66, s66, s71
    s_add_u32 s75, s75, 1
    s_cbranch_scc0 L_l0
    s_add_u32 s66, s66, 523776
    s_mov_b32 s75, -4
    s_add_u32 s77, s77, 1
    s_cbranch_scc0 L_l0
L_l1:
    v_lshlrev_b32 v19, 2, v1
    v_add_u32 v19, 143104, v19
    v_writelane_b32 v19, s63, 0
    s_lshr_b32 s72, s73, 13
    s_mov_b32 s74, 0
    s_cmp_ge_u32 s6, 16
    s_cbranch_scc1 L_LB
    s_barrier
    s_branch L_lrest
L_compute:
    v_lshlrev_b32 v13, 2, v1
    v_mov_b32 v16, 0
    v_add_u32 v17, v13, v14
    ds_write_b32 v17, v16 offset:0
    s_cmp_ge_u32 s6, 16
    s_cbranch_scc1 L_eB
    v_bfe_u32 v8, v1, 1, 3
    v_lshlrev_b32 v8, 11, v8
    v_lshl_add_u32 v8, v2, 3, v8
    v_and_b32 v9, 1, v1
    v_lshl_add_u32 v8, v9, 5, v8
    s_and_b32 s71, s6, 3
    s_lshl_b32 s67, s71, 9
    s_lshl_b32 s70, s3, 6
    s_add_u32 s67, s67, s70
    s_waitcnt lgkmcnt(0)
    buffer_load_dwordx2 v[28:29], v8, s[40:43], s67 offen
    s_load_dword s64, s[52:53], 0
    s_barrier
    s_branch L_eD
L_eB:
    v_lshlrev_b32 v9, 4, v1
    s_lshl_b32 s70, s3, 11
    v_bfe_u32 v10, v1, 3, 2
    v_lshlrev_b32 v8, 11, v4
    v_lshl_add_u32 v8, v10, 3, v8
    v_lshrrev_b32 v10, 5, v1
    v_lshl_add_u32 v8, v10, 2, v8
    s_lshl_b32 s69, s5, 8
    s_lshl_b32 s67, s3, 5
    s_add_u32 s69, s69, s67
    s_waitcnt lgkmcnt(0)
    buffer_load_dwordx4 v[32:35], v9, s[8:11], s70 offen
    buffer_load_dwordx4 v[36:39], v9, s[8:11], s70 offen offset:1024
    buffer_load_dword v58, v8, s[8:11], s69 offen
    s_and_b32 s69, s6, 1
    s_lshl_b32 s69, s69, 1
    s_and_b32 s67, s6, 3
    s_cmp_lt_u32 s6, 24
    s_cselect_b32 s69, s69, s67
    s_lshl_b32 s69, s69, 8
    s_lshl_b32 s67, s3, 6
    s_add_u32 s69, s69, s67
    s_and_b32 s69, s69, 1023
    s_lshl_b32 s69, s69, 1
    v_lshlrev_b32 v8, 11, v4
    v_lshl_add_u32 v8, v5, 6, v8
    v_lshl_add_u32 v8, v2, 3, v8
    buffer_load_dwordx2 v[96:97], v8, s[40:43], s69 offen offset:0
    buffer_load_dwordx2 v[98:99], v8, s[40:43], s69 offen offset:32
    s_load_dword s64, s[52:53], 0
L_eD:
    v_mov_b32 v6, 0xff
    v_mov_b32 v15, 1
    s_mov_b32 s7, 0x07060302
    s_mov_b32 s84, 0x00ff00ff
    s_mov_b32 s85, 0x00ff00ff
    s_mov_b32 s88, 0x3fb8aa3b
    v_lshrrev_b32 v8, 2, v1
    v_lshlrev_b32 v8, 7, v8
    v_and_b32 v9, 3, v1
    v_lshl_add_u32 v8, v9, 3, v8
    v_bfe_u32 v9, v1, 3, 2
    v_lshl_add_u32 v160, v9, 5, v8
    v_xor_b32 v161, 32, v160
    v_xor_b32 v162, 64, v160
    v_xor_b32 v163, 96, v160
    s_cmp_ge_u32 s6, 16
    s_cbranch_scc1 L_B
    s_lshl_b32 s67, s3, 9
    v_lshl_add_u32 v8, v1, 3, v14
    v_add_u32 v8, s67, v8
    s_lshl_b32 s70, s5, 15
    s_bfe_u32 s67, s6, 0x20002
    s_lshl_b32 s67, s67, 13
    s_add_u32 s70, s70, s67
    s_lshl_b32 s67, s3, 11
    s_add_u32 s70, s70, s67
    s_lshl_b32 s67, s71, 9
    s_add_u32 s70, s70, s67
    s_add_u32 s70, s70, 4096
    s_add_u32 s72, s70, 4194304
    v_lshlrev_b32 v10, 4, v4
    v_lshl_add_u32 v10, v2, 7, v10
    v_add_u32 v30, v10, v14
    s_lshl_b32 s67, s3, 5
    v_xor_b32 v9, s67, v160
    s_waitcnt vmcnt(0)
    v_lshlrev_b32 v32, 16, v28
    v_and_b32 v33, 0xffff0000, v28
    v_lshlrev_b32 v34, 16, v29
    v_and_b32 v35, 0xffff0000, v29
    v_mul_f32 v40, 0xbfb8aa3b, v32
    v_mul_f32 v41, 0xbfb8aa3b, v33
    v_mul_f32 v42, 0xbfb8aa3b, v34
    v_mul_f32 v43, 0xbfb8aa3b, v35
    v_exp_f32 v40, v40
    v_exp_f32 v41, v41
    v_exp_f32 v42, v42
    v_exp_f32 v43, v43
    v_add_f32 v40, 1.0, v40
    v_add_f32 v41, 1.0, v41
    v_add_f32 v42, 1.0, v42
    v_add_f32 v43, 1.0, v43
    v_rcp_f32 v40, v40
    v_rcp_f32 v41, v41
    v_rcp_f32 v42, v42
    v_rcp_f32 v43, v43
    v_mul_f32 v32, v32, v40
    v_mul_f32 v33, v33, v41
    v_mul_f32 v34, v34, v42
    v_mul_f32 v35, v35, v43
    v_cvt_pk_bf16_f32 v32, v32, v33
    v_cvt_pk_bf16_f32 v33, v34, v35
    s_waitcnt lgkmcnt(0)
    s_add_u32 s4, s64, 1
    s_and_b32 s4, s4, 0xff
    ds_write_b64 v8, v[32:33] offset:2688
    s_mov_b64 exec, 1
    ds_add_u32 v14, v15 offset:80
    s_mov_b64 exec, -1
    s_cmp_ge_u32 s3, 4
    s_cbranch_scc1 L_att
    ds_read_b32 v24, v14 offset:80
    ds_read_b128 v[96:99], v30 offset:2688
    ds_read_b128 v[100:103], v30 offset:3200
    ds_read_b128 v[104:107], v30 offset:3712
    ds_read_b128 v[108:111], v30 offset:4224
    ds_read_b128 v[112:115], v30 offset:4736
    ds_read_b128 v[116:119], v30 offset:5248
    ds_read_b128 v[120:123], v30 offset:5760
    ds_read_b128 v[124:127], v30 offset:6272
    s_waitcnt lgkmcnt(8)
    v_cmp_le_i32 vcc, 8, v24
    s_cbranch_vccnz L_lwe_3
    s_mov_b32 s80, 160000
L_lw_1:
    ds_read_b32 v24, v14 offset:80
    s_waitcnt lgkmcnt(0)
    v_cmp_le_i32 vcc, 8, v24
    s_sub_u32 s80, s80, 1
    s_cbranch_vccnz L_lwd_2
    s_cmp_lg_u32 s80, 0
    s_cbranch_scc1 L_lw_1
L_lwd_2:
    ds_read_b128 v[96:99], v30 offset:2688
    ds_read_b128 v[100:103], v30 offset:3200
    ds_read_b128 v[104:107], v30 offset:3712
    ds_read_b128 v[108:111], v30 offset:4224
    ds_read_b128 v[112:115], v30 offset:4736
    ds_read_b128 v[116:119], v30 offset:5248
    ds_read_b128 v[120:123], v30 offset:5760
    ds_read_b128 v[124:127], v30 offset:6272
L_lwe_3:
    s_waitcnt lgkmcnt(0)
    ds_read_b32 v24, v14 offset:0
    ds_read_b64_tr_b16 v[128:129], v9 offset:0
    ds_read_b64_tr_b16 v[130:131], v9 offset:2048
    ds_read_b64_tr_b16 v[132:133], v9 offset:4096
    ds_read_b64_tr_b16 v[134:135], v9 offset:6144
    s_waitcnt lgkmcnt(4)
    v_cmp_le_i32 vcc, 1, v24
    s_cbranch_vccnz L_lwe_6
    s_mov_b32 s80, 160000
L_lw_4:
    ds_read_b32 v24, v14 offset:0
    s_waitcnt lgkmcnt(0)
    v_cmp_le_i32 vcc, 1, v24
    s_sub_u32 s80, s80, 1
    s_cbranch_vccnz L_lwd_5
    s_cmp_lg_u32 s80, 0
    s_cbranch_scc1 L_lw_4
L_lwd_5:
    ds_read_b64_tr_b16 v[128:129], v9 offset:0
    ds_read_b64_tr_b16 v[130:131], v9 offset:2048
    ds_read_b64_tr_b16 v[132:133], v9 offset:4096
    ds_read_b64_tr_b16 v[134:135], v9 offset:6144
L_lwe_6:
    s_waitcnt lgkmcnt(2)
    v_mfma_f32_16x16x32_bf16 v[16:19], v[128:131], v[96:99], 0
    s_waitcnt lgkmcnt(0)
    v_mfma_f32_16x16x32_bf16 v[20:23], v[132:135], v[100:103], 0
    ds_read_b32 v24, v14 offset:0
    ds_read_b64_tr_b16 v[136:137], v9 offset:8192
    ds_read_b64_tr_b16 v[138:139], v9 offset:10240
    ds_read_b64_tr_b16 v[140:141], v9 offset:12288
    ds_read_b64_tr_b16 v[142:143], v9 offset:14336
    s_waitcnt lgkmcnt(4)
    v_cmp_le_i32 vcc, 2, v24
    s_cbranch_vccnz L_lwe_9
    s_mov_b32 s80, 160000
L_lw_7:
    ds_read_b32 v24, v14 offset:0
    s_waitcnt lgkmcnt(0)
    v_cmp_le_i32 vcc, 2, v24
    s_sub_u32 s80, s80, 1
    s_cbranch_vccnz L_lwd_8
    s_cmp_lg_u32 s80, 0
    s_cbranch_scc1 L_lw_7
L_lwd_8:
    ds_read_b64_tr_b16 v[136:137], v9 offset:8192
    ds_read_b64_tr_b16 v[138:139], v9 offset:10240
    ds_read_b64_tr_b16 v[140:141], v9 offset:12288
    ds_read_b64_tr_b16 v[142:143], v9 offset:14336
L_lwe_9:
    s_waitcnt lgkmcnt(2)
    v_mfma_f32_16x16x32_bf16 v[16:19], v[136:139], v[104:107], v[16:19]
    s_waitcnt lgkmcnt(0)
    v_mfma_f32_16x16x32_bf16 v[20:23], v[140:143], v[108:111], v[20:23]
    ds_read_b32 v24, v14 offset:0
    ds_read_b64_tr_b16 v[144:145], v9 offset:16384
    ds_read_b64_tr_b16 v[146:147], v9 offset:18432
    ds_read_b64_tr_b16 v[148:149], v9 offset:20480
    ds_read_b64_tr_b16 v[150:151], v9 offset:22528
    s_waitcnt lgkmcnt(4)
    v_cmp_le_i32 vcc, 3, v24
    s_cbranch_vccnz L_lwe_12
    s_mov_b32 s80, 160000
L_lw_10:
    ds_read_b32 v24, v14 offset:0
    s_waitcnt lgkmcnt(0)
    v_cmp_le_i32 vcc, 3, v24
    s_sub_u32 s80, s80, 1
    s_cbranch_vccnz L_lwd_11
    s_cmp_lg_u32 s80, 0
    s_cbranch_scc1 L_lw_10
L_lwd_11:
    ds_read_b64_tr_b16 v[144:145], v9 offset:16384
    ds_read_b64_tr_b16 v[146:147], v9 offset:18432
    ds_read_b64_tr_b16 v[148:149], v9 offset:20480
    ds_read_b64_tr_b16 v[150:151], v9 offset:22528
L_lwe_12:
    s_waitcnt lgkmcnt(2)
    v_mfma_f32_16x16x32_bf16 v[16:19], v[144:147], v[112:115], v[16:19]
    s_waitcnt lgkmcnt(0)
    v_mfma_f32_16x16x32_bf16 v[20:23], v[148:151], v[116:119], v[20:23]
    ds_read_b32 v24, v14 offset:0
    ds_read_b64_tr_b16 v[152:153], v9 offset:24576
    ds_read_b64_tr_b16 v[154:155], v9 offset:26624
    ds_read_b64_tr_b16 v[156:157], v9 offset:28672
    ds_read_b64_tr_b16 v[158:159], v9 offset:30720
    s_waitcnt lgkmcnt(4)
    v_cmp_le_i32 vcc, 4, v24
    s_cbranch_vccnz L_lwe_15
    s_mov_b32 s80, 160000
L_lw_13:
    ds_read_b32 v24, v14 offset:0
    s_waitcnt lgkmcnt(0)
    v_cmp_le_i32 vcc, 4, v24
    s_sub_u32 s80, s80, 1
    s_cbranch_vccnz L_lwd_14
    s_cmp_lg_u32 s80, 0
    s_cbranch_scc1 L_lw_13
L_lwd_14:
    ds_read_b64_tr_b16 v[152:153], v9 offset:24576
    ds_read_b64_tr_b16 v[154:155], v9 offset:26624
    ds_read_b64_tr_b16 v[156:157], v9 offset:28672
    ds_read_b64_tr_b16 v[158:159], v9 offset:30720
L_lwe_15:
    s_waitcnt lgkmcnt(2)
    v_mfma_f32_16x16x32_bf16 v[16:19], v[152:155], v[120:123], v[16:19]
    s_waitcnt lgkmcnt(0)
    v_mfma_f32_16x16x32_bf16 v[20:23], v[156:159], v[124:127], v[20:23]
    s_nop 7
    v_add_f32 v16, v16, v20
    v_add_f32 v17, v17, v21
    v_add_f32 v18, v18, v22
    v_add_f32 v19, v19, v23
    v_bfi_b32 v16, v6, s4, v16
    v_bfi_b32 v17, v6, s4, v17
    v_bfi_b32 v18, v6, s4, v18
    v_bfi_b32 v19, v6, s4, v19
    s_mov_b64 exec, s[84:85]
    buffer_store_dwordx4 v[16:19], v10, s[52:55], s72 offen
    buffer_store_dwordx4 v[16:19], v10, s[52:55], s70 offen sc1
    s_mov_b64 exec, 1
    ds_add_u32 v14, v15 offset:136
    s_mov_b64 exec, -1
    v_mov_b32 v20, 2
    v_add_u32 v16, v13, v14
    s_mov_b64 exec, 0xf
    ds_add_u32 v16, v20 offset:4
    s_mov_b64 exec, -1
    s_branch L_att
L_B:
    s_sub_u32 s68, s6, 16
    s_lshl_b32 s70, s5, 17
    s_lshl_b32 s67, s68, 10
    s_add_u32 s70, s70, s67
    s_lshl_b32 s67, s3, 7
    s_add_u32 s70, s70, s67
    s_add_u32 s70, s70, 659456
    s_add_u32 s71, s70, 4194304
    v_lshlrev_b32 v31, 14, v4
    v_lshl_add_u32 v31, v5, 6, v31
    v_lshl_add_u32 v31, v2, 4, v31
    v_and_b32 v30, 31, v1
    v_lshl_add_u32 v28, v30, 4, v14
    s_lshr_b32 s67, s3, 1
    s_lshl_b32 s67, s67, 9
    s_and_b32 s72, s3, 1
    s_lshl_b32 s72, s72, 3
    s_add_u32 s67, s67, s72
    v_add_u32 v28, s67, v28
    v_lshl_add_u32 v29, v4, 4, v14
    v_lshl_add_u32 v29, v2, 7, v29
    v_lshrrev_b32 v27, 5, v1
    v_lshl_add_u32 v28, v27, 2, v28
    v_lshlrev_b32 v27, 14, v27
    v_lshl_add_u32 v27, v30, 4, v27
    s_and_b32 s67, s3, 3
    s_lshl_b32 s67, s67, 9
    v_add_u32 v26, s67, v27
    s_lshl_b32 s73, s5, 15
    s_lshl_b32 s67, s3, 11
    s_add_u32 s73, s73, s67
    s_add_u32 s73, s73, 4096
    s_waitcnt vmcnt(3)
    v_lshlrev_b32 v40, 16, v32
    v_and_b32 v41, 0xffff0000, v32
    v_lshlrev_b32 v42, 16, v33
    v_and_b32 v43, 0xffff0000, v33
    v_lshlrev_b32 v44, 16, v34
    v_and_b32 v45, 0xffff0000, v34
    v_lshlrev_b32 v46, 16, v35
    v_and_b32 v47, 0xffff0000, v35
    v_lshlrev_b32 v48, 16, v36
    v_and_b32 v49, 0xffff0000, v36
    v_lshlrev_b32 v50, 16, v37
    v_and_b32 v51, 0xffff0000, v37
    v_lshlrev_b32 v52, 16, v38
    v_and_b32 v53, 0xffff0000, v38
    v_lshlrev_b32 v54, 16, v39
    v_and_b32 v55, 0xffff0000, v39
    v_add_f32 v18, v40, v41
    v_add_f32 v18, v18, v42
    v_add_f32 v18, v18, v43
    v_add_f32 v18, v18, v44
    v_add_f32 v18, v18, v45
    v_add_f32 v18, v18, v46
    v_add_f32 v18, v18, v47
    v_add_f32 v18, v18, v48
    v_add_f32 v18, v18, v49
    v_add_f32 v18, v18, v50
    v_add_f32 v18, v18, v51
    v_add_f32 v18, v18, v52
    v_add_f32 v18, v18, v53
    v_add_f32 v18, v18, v54
    v_add_f32 v18, v18, v55
    s_nop 1
    v_add_f32_dpp v19, v18, v18 quad_perm:[1,0,3,2] row_mask:0xf bank_mask:0xf
    s_nop 1
    v_add_f32_dpp v18, v19, v19 quad_perm:[2,3,0,1] row_mask:0xf bank_mask:0xf
    s_nop 1
    v_add_f32_dpp v19, v18, v18 row_half_mirror row_mask:0xf bank_mask:0xf
    s_nop 1
    v_add_f32_dpp v18, v19, v19 row_ror:8 row_mask:0xf bank_mask:0xf
    v_mov_b32 v19, v18
    s_nop 1
    v_permlane16_swap_b32 v18, v19
    v_add_f32 v18, v18, v19
    v_mov_b32 v19, v18
    s_nop 1
    v_permlane32_swap_b32 v18, v19
    v_add_f32 v18, v18, v19
    v_mul_f32 v18, 0x3a800000, v18
    v_mov_b32 v16, 0
    v_sub_f32 v17, v40, v18
    v_fmac_f32 v16, v17, v17
    v_sub_f32 v17, v41, v18
    v_fmac_f32 v16, v17, v17
    v_sub_f32 v17, v42, v18
    v_fmac_f32 v16, v17, v17
    v_sub_f32 v17, v43, v18
    v_fmac_f32 v16, v17, v17
    v_sub_f32 v17, v44, v18
    v_fmac_f32 v16, v17, v17
    v_sub_f32 v17, v45, v18
    v_fmac_f32 v16, v17, v17
    v_sub_f32 v17, v46, v18
    v_fmac_f32 v16, v17, v17
    v_sub_f32 v17, v47, v18
    v_fmac_f32 v16, v17, v17
    v_sub_f32 v17, v48, v18
    v_fmac_f32 v16, v17, v17
    v_sub_f32 v17, v49, v18
    v_fmac_f32 v16, v17, v17
    v_sub_f32 v17, v50, v18
    v_fmac_f32 v16, v17, v17
    v_sub_f32 v17, v51, v18
    v_fmac_f32 v16, v17, v17
    v_sub_f32 v17, v52, v18
    v_fmac_f32 v16, v17, v17
    v_sub_f32 v17, v53, v18
    v_fmac_f32 v16, v17, v17
    v_sub_f32 v17, v54, v18
    v_fmac_f32 v16, v17, v17
    v_sub_f32 v17, v55, v18
    v_fmac_f32 v16, v17, v17
    s_nop 1
    v_add_f32_dpp v19, v16, v16 quad_perm:[1,0,3,2] row_mask:0xf bank_mask:0xf
    s_nop 1
    v_add_f32_dpp v16, v19, v19 quad_perm:[2,3,0,1] row_mask:0xf bank_mask:0xf
    s_nop 1
    v_add_f32_dpp v19, v16, v16 row_half_mirror row_mask:0xf bank_mask:0xf
    s_nop 1
    v_add_f32_dpp v16, v19, v19 row_ror:8 row_mask:0xf bank_mask:0xf
    v_mov_b32 v19, v16
    s_nop 1
    v_permlane16_swap_b32 v16, v19
    v_add_f32 v16, v16, v19
    v_mov_b32 v19, v16
    s_nop 1
    v_permlane32_swap_b32 v16, v19
    v_add_f32 v16, v16, v19
    v_mul_f32 v19, 0x3a800000, v16
    v_cvt_pk_bf16_f32 v16, v18, v19
    v_lshlrev_b32 v18, 16, v16
    v_and_b32 v19, 0xffff0000, v16
    v_add_f32 v19, 0x3727c5ac, v19
    v_cvt_pk_bf16_f32 v19, v19, v19
    v_lshlrev_b32 v19, 16, v19
    v_sqrt_f32 v19, v19
    s_nop 0
    v_cvt_pk_bf16_f32 v19, v19, v19
    v_lshlrev_b32 v19, 16, v19
    v_rcp_f32 v19, v19
    s_lshl_b32 s67, s3, 3
    v_add_u32 v16, s67, v14
    s_waitcnt lgkmcnt(0)
    s_add_u32 s4, s64, 1
    s_and_b32 s4, s4, 0xff
    s_barrier
    ds_write_b64 v16, v[18:19] offset:256
    s_mov_b64 exec, 1
    ds_add_u32 v14, v15 offset:80
    s_mov_b64 exec, -1
    s_waitcnt vmcnt(0)
    v_lshl_add_u32 v17, v4, 3, v14
    v_lshlrev_b32 v60, 16, v58
    v_and_b32 v61, 0xffff0000, v58
    v_lshlrev_b32 v32, 16, v96
    v_and_b32 v33, 0xffff0000, v96
    v_lshlrev_b32 v34, 16, v97
    v_and_b32 v35, 0xffff0000, v97
    v_lshlrev_b32 v36, 16, v98
    v_and_b32 v37, 0xffff0000, v98
    v_lshlrev_b32 v38, 16, v99
    v_and_b32 v39, 0xffff0000, v99
    v_mul_f32 v40, 0xbfb8aa3b, v32
    v_mul_f32 v41, 0xbfb8aa3b, v33
    v_mul_f32 v42, 0xbfb8aa3b, v34
    v_mul_f32 v43, 0xbfb8aa3b, v35
    v_mul_f32 v44, 0xbfb8aa3b, v36
    v_mul_f32 v45, 0xbfb8aa3b, v37
    v_mul_f32 v46, 0xbfb8aa3b, v38
    v_mul_f32 v47, 0xbfb8aa3b, v39
    v_exp_f32 v40, v40
    v_exp_f32 v41, v41
    v_exp_f32 v42, v42
    v_exp_f32 v43, v43
    v_exp_f32 v44, v44
    v_exp_f32 v45, v45
    v_exp_f32 v46, v46
    v_exp_f32 v47, v47
    v_add_f32 v40, 1.0, v40
    v_add_f32 v41, 1.0, v41
    v_add_f32 v42, 1.0, v42
    v_add_f32 v43, 1.0, v43
    v_add_f32 v44, 1.0, v44
    v_add_f32 v45, 1.0, v45
    v_add_f32 v46, 1.0, v46
    v_add_f32 v47, 1.0, v47
    v_rcp_f32 v40, v40
    v_rcp_f32 v41, v41
    v_rcp_f32 v42, v42
    v_rcp_f32 v43, v43
    v_rcp_f32 v44, v44
    v_rcp_f32 v45, v45
    v_rcp_f32 v46, v46
    v_rcp_f32 v47, v47
    v_mul_f32 v32, v32, v40
    v_mul_f32 v33, v33, v41
    v_mul_f32 v34, v34, v42
    v_mul_f32 v35, v35, v43
    v_mul_f32 v36, v36, v44
    v_mul_f32 v37, v37, v45
    v_mul_f32 v38, v38, v46
    v_mul_f32 v39, v39, v47
    v_cvt_pk_bf16_f32 v100, v32, v33
    v_cvt_pk_bf16_f32 v101, v34, v35
    v_cvt_pk_bf16_f32 v102, v36, v37
    v_cvt_pk_bf16_f32 v103, v38, v39
    ds_read_b32 v16, v14 offset:80
    ds_read_b64 v[18:19], v17 offset:256
    s_waitcnt lgkmcnt(1)
    v_cmp_le_i32 vcc, 8, v16
    s_cbranch_vccnz L_lwe_18
    s_mov_b32 s80, 160000
L_lw_16:
    ds_read_b32 v16, v14 offset:80
    s_waitcnt lgkmcnt(0)
    v_cmp_le_i32 vcc, 8, v16
    s_sub_u32 s80, s80, 1
    s_cbranch_vccnz L_lwd_17
    s_cmp_lg_u32 s80, 0
    s_cbranch_scc1 L_lw_16
L_lwd_17:
    ds_read_b64 v[18:19], v17 offset:256
L_lwe_18:
    s_waitcnt lgkmcnt(0)
    v_sub_f32 v60, v60, v18
    v_sub_f32 v61, v61, v18
    v_cvt_pk_bf16_f32 v24, v60, v61
    v_lshlrev_b32 v60, 16, v24
    v_and_b32 v61, 0xffff0000, v24
    v_mul_f32 v60, v60, v19
    v_mul_f32 v61, v61, v19
    v_cvt_pk_bf16_f32 v24, v60, v61
    v_lshlrev_b32 v60, 16, v24
    v_and_b32 v61, 0xffff0000, v24
    s_lshr_b32 s78, s3, 1
    s_add_u32 s79, s78, 1
    s_lshl_b32 s78, s78, 13
    s_lshl_b32 s67, s72, 3
    v_xor_b32 v16, s67, v160
    v_add_u32 v164, s78, v16
    v_xor_b32 v16, s67, v161
    v_add_u32 v165, s78, v16
    s_mov_b32 s80, 160000
L_lw_19:
    ds_read_b32 v16, v14 offset:0
    s_waitcnt lgkmcnt(0)
    v_cmp_le_i32 vcc, s79, v16
    s_sub_u32 s80, s80, 1
    s_cbranch_vccnz L_lwd_20
    s_nop 15
    s_nop 15
    s_nop 15
    s_cmp_lg_u32 s80, 0
    s_cbranch_scc1 L_lw_19
L_lwd_20:
L_lwe_21:
    ds_read_b64_tr_b16 v[64:65], v164 offset:0
    ds_read_b64_tr_b16 v[66:67], v164 offset:2048
    ds_read_b64_tr_b16 v[68:69], v164 offset:4096
    ds_read_b64_tr_b16 v[70:71], v164 offset:6144
    ds_read_b64_tr_b16 v[72:73], v165 offset:0
    ds_read_b64_tr_b16 v[74:75], v165 offset:2048
    ds_read_b64_tr_b16 v[76:77], v165 offset:4096
    ds_read_b64_tr_b16 v[78:79], v165 offset:6144
    s_add_u32 s79, s79, 4
    s_mov_b32 s75, 0
    s_mov_b32 exec_lo, 0x1
    s_mov_b32 exec_hi, 0x1
    s_add_u32 s74, s73, 4194304
    s_mov_b32 s80, 20007
L_poll_22:
    buffer_load_dword v25, v26, s[52:55], s74 offen sc1
    s_cmp_lg_u32 s75, 0
    s_cbranch_scc1 L_hk_24
    ds_read_b32 v16, v14 offset:0
    s_waitcnt lgkmcnt(0)
    v_cmp_le_i32 vcc, s79, v16
    s_cbranch_vccz L_hk_24
    s_mov_b64 exec, -1
    ds_read_b64_tr_b16 v[80:81], v164 offset:32768
    ds_read_b64_tr_b16 v[82:83], v164 offset:34816
    ds_read_b64_tr_b16 v[84:85], v164 offset:36864
    ds_read_b64_tr_b16 v[86:87], v164 offset:38912
    ds_read_b64_tr_b16 v[88:89], v165 offset:32768
    ds_read_b64_tr_b16 v[90:91], v165 offset:34816
    ds_read_b64_tr_b16 v[92:93], v165 offset:36864
    ds_read_b64_tr_b16 v[94:95], v165 offset:38912
    s_mov_b32 exec_lo, 0x1
    s_mov_b32 exec_hi, 0x1
    s_mov_b32 s75, 1
L_hk_24:
    s_waitcnt vmcnt(0)
    v_xor_b32 v24, s4, v25
    v_and_b32 v24, v6, v24
    v_cmp_ne_u32 vcc, 0, v24
    s_sub_u32 s80, s80, 1
    s_cbranch_vccz L_pdone_23
    s_and_b32 s81, s80, 7
    s_cselect_b32 s81, 4194304, 0
    s_add_u32 s74, s73, s81
    s_cmp_lg_u32 s80, 0
    s_cbranch_scc1 L_poll_22
L_pdone_23:
    s_mov_b64 exec, -1
    s_mov_b32 s80, 20007
L_poll_25:
    buffer_load_dwordx4 v[32:35], v27, s[52:55], s74 offen offset:0 sc1
    buffer_load_dwordx4 v[36:39], v27, s[52:55], s74 offen offset:512 sc1
    buffer_load_dwordx4 v[40:43], v27, s[52:55], s74 offen offset:1024 sc1
    buffer_load_dwordx4 v[44:47], v27, s[52:55], s74 offen offset:1536 sc1
    s_waitcnt vmcnt(3)
    v_xor_b32 v24, s4, v32
    v_bitop3_b32 v24, v33, v24, s4 bitop3:0xde
    v_bitop3_b32 v24, v34, v24, s4 bitop3:0xde
    v_bitop3_b32 v24, v35, v24, s4 bitop3:0xde
    s_waitcnt vmcnt(2)
    v_bitop3_b32 v24, v36, v24, s4 bitop3:0xde
    v_bitop3_b32 v24, v37, v24, s4 bitop3:0xde
    v_bitop3_b32 v24, v38, v24, s4 bitop3:0xde
    v_bitop3_b32 v24, v39, v24, s4 bitop3:0xde
    s_waitcnt vmcnt(1)
    v_bitop3_b32 v24, v40, v24, s4 bitop3:0xde
    v_bitop3_b32 v24, v41, v24, s4 bitop3:0xde
    v_bitop3_b32 v24, v42, v24, s4 bitop3:0xde
    v_bitop3_b32 v24, v43, v24, s4 bitop3:0xde
    s_waitcnt vmcnt(0)
    v_bitop3_b32 v24, v44, v24, s4 bitop3:0xde
    v_bitop3_b32 v24, v45, v24, s4 bitop3:0xde
    v_bitop3_b32 v24, v46, v24, s4 bitop3:0xde
    v_bitop3_b32 v24, v47, v24, s4 bitop3:0xde
    v_and_b32 v24, v6, v24
    v_cmp_ne_u32 vcc, 0, v24
    s_sub_u32 s80, s80, 1
    s_cbranch_vccz L_pdone_26
    s_and_b32 s81, s80, 7
    s_cselect_b32 s81, 4194304, 0
    s_add_u32 s74, s73, s81
    s_cmp_lg_u32 s80, 0
    s_cbranch_scc1 L_poll_25
L_pdone_26:
    v_add_f32 v32, v32, v36
    v_add_f32 v40, v40, v44
    v_add_f32 v33, v33, v37
    v_add_f32 v41, v41, v45
    v_add_f32 v34, v34, v38
    v_add_f32 v42, v42, v46
    v_add_f32 v35, v35, v39
    v_add_f32 v43, v43, v47
    v_add_f32 v32, v32, v40
    v_add_f32 v33, v33, v41
    v_add_f32 v34, v34, v42
    v_add_f32 v35, v35, v43
    s_nop 0
    v_permlane32_swap_b32 v32, v34
    v_permlane32_swap_b32 v33, v35
    v_cvt_pk_bf16_f32 v24, v34, v35
    v_lshlrev_b32 v34, 16, v24
    v_and_b32 v35, 0xffff0000, v24
    v_add_f32 v34, 1.0, v34
    v_add_f32 v35, 1.0, v35
    v_cvt_pk_bf16_f32 v24, v34, v35
    v_lshlrev_b32 v34, 16, v24
    v_and_b32 v35, 0xffff0000, v24
    v_cvt_pk_bf16_f32 v25, v32, v33
    v_lshlrev_b32 v32, 16, v25
    v_and_b32 v33, 0xffff0000, v25
    v_mul_f32 v34, v60, v34
    v_mul_f32 v35, v61, v35
    v_cvt_pk_bf16_f32 v24, v34, v35
    v_lshlrev_b32 v34, 16, v24
    v_and_b32 v35, 0xffff0000, v24
    v_add_f32 v32, v32, v34
    v_add_f32 v33, v33, v35
    v_cvt_pk_bf16_f32 v32, v32, v33
    ds_write_b32 v28, v32 offset:512
    s_mov_b64 exec, 1
    ds_add_u32 v14, v15 offset:84
    s_mov_b64 exec, -1
    s_cmp_lg_u32 s75, 0
    s_cbranch_scc1 L_lp_27
    ds_read_b32 v24, v14 offset:0
    ds_read_b64_tr_b16 v[80:81], v164 offset:32768
    ds_read_b64_tr_b16 v[82:83], v164 offset:34816
    ds_read_b64_tr_b16 v[84:85], v164 offset:36864
    ds_read_b64_tr_b16 v[86:87], v164 offset:38912
    ds_read_b64_tr_b16 v[88:89], v165 offset:32768
    ds_read_b64_tr_b16 v[90:91], v165 offset:34816
    ds_read_b64_tr_b16 v[92:93], v165 offset:36864
    ds_read_b64_tr_b16 v[94:95], v165 offset:38912
    s_waitcnt lgkmcnt(8)
    v_cmp_le_i32 vcc, s79, v24
    s_cbranch_vccnz L_lwe_30
    s_mov_b32 s80, 160000
L_lw_28:
    ds_read_b32 v24, v14 offset:0
    s_waitcnt lgkmcnt(0)
    v_cmp_le_i32 vcc, s79, v24
    s_sub_u32 s80, s80, 1
    s_cbranch_vccnz L_lwd_29
    s_cmp_lg_u32 s80, 0
    s_cbranch_scc1 L_lw_28
L_lwd_29:
    ds_read_b64_tr_b16 v[80:81], v164 offset:32768
    ds_read_b64_tr_b16 v[82:83], v164 offset:34816
    ds_read_b64_tr_b16 v[84:85], v164 offset:36864
    ds_read_b64_tr_b16 v[86:87], v164 offset:38912
    ds_read_b64_tr_b16 v[88:89], v165 offset:32768
    ds_read_b64_tr_b16 v[90:91], v165 offset:34816
    ds_read_b64_tr_b16 v[92:93], v165 offset:36864
    ds_read_b64_tr_b16 v[94:95], v165 offset:38912
L_lwe_30:
L_lp_27:
    s_mov_b32 s80, 160000
L_lw_31:
    ds_read_b32 v24, v14 offset:84
    ds_read_b128 v[32:35], v29 offset:512
    ds_read_b128 v[36:39], v29 offset:1024
    ds_read_b128 v[40:43], v29 offset:1536
    ds_read_b128 v[44:47], v29 offset:2048
    s_sub_u32 s80, s80, 1
    s_cbranch_scc1 L_lwe_33
    s_waitcnt lgkmcnt(4)
    v_cmp_le_i32 vcc, 8, v24
    s_cbranch_vccz L_lw_31
L_lwe_33:
    s_waitcnt lgkmcnt(3)
    v_mfma_f32_16x16x32_bf16 v[16:19], v[64:67], v[32:35], 0
    v_mfma_f32_16x16x32_bf16 v[20:23], v[72:75], v[32:35], 0
    s_waitcnt lgkmcnt(2)
    v_mfma_f32_16x16x32_bf16 v[16:19], v[68:71], v[36:39], v[16:19]
    v_mfma_f32_16x16x32_bf16 v[20:23], v[76:79], v[36:39], v[20:23]
    s_waitcnt lgkmcnt(1)
    v_mfma_f32_16x16x32_bf16 v[16:19], v[80:83], v[40:43], v[16:19]
    v_mfma_f32_16x16x32_bf16 v[20:23], v[88:91], v[40:43], v[20:23]
    s_waitcnt lgkmcnt(0)
    v_mfma_f32_16x16x32_bf16 v[16:19], v[84:87], v[44:47], v[16:19]
    v_mfma_f32_16x16x32_bf16 v[20:23], v[92:95], v[44:47], v[20:23]
    s_lshr_b32 s67, s68, 2
    s_cmp_lg_u32 s67, s65
    s_nop 5
    v_cndmask_b32 v16, v20, v16, s[84:85]
    v_cndmask_b32 v17, v21, v17, s[84:85]
    v_cndmask_b32 v18, v22, v18, s[84:85]
    v_cndmask_b32 v19, v23, v19, s[84:85]
    v_bfi_b32 v16, v6, s4, v16
    v_bfi_b32 v17, v6, s4, v17
    v_bfi_b32 v18, v6, s4, v18
    v_bfi_b32 v19, v6, s4, v19
    buffer_store_dwordx4 v[16:19], v31, s[52:55], s70 offen sc1
    s_cbranch_scc1 L_nopl_34
    buffer_store_dwordx4 v[16:19], v31, s[52:55], s71 offen
L_nopl_34:
    s_mov_b64 exec, 1
    ds_add_u32 v14, v15 offset:88
    s_mov_b64 exec, -1
    s_lshr_b32 s67, s78, 11
    v_add_u32 v24, s67, v14
    v_mov_b32 v25, 4
    s_mov_b64 exec, 1
    ds_add_u32 v24, v25 offset:4
    ds_add_u32 v24, v25 offset:20
    s_mov_b64 exec, -1
    s_and_b32 s69, s6, 1
    s_lshl_b32 s69, s69, 1
    s_and_b32 s67, s6, 3
    s_cmp_lt_u32 s6, 24
    s_cselect_b32 s69, s69, s67
    s_lshl_b32 s69, s69, 8
    s_bfe_u32 s72, s6, 0x30001
    s_min_u32 s72, s72, 4
    s_mul_i32 s67, s5, 5
    s_add_u32 s72, s72, s67
    s_cmp_lt_u32 s6, 28
    s_cbranch_scc1 L_rmt_35
    s_lshl3_add_u32 s72, s5, 3
    s_cmp_lt_u32 s5, 6
    s_cbranch_scc1 L_rmt_36
    s_add_u32 s72, s5, 34
L_rmt_35:
    s_add_u32 s67, s72, 4
    s_mul_i32 s67, s67, 37
    s_lshr_b32 s67, s67, 8
    s_add_u32 s72, s72, s67
L_rmt_36:
    s_cmp_ge_u32 s6, 24
    s_cselect_b32 s70, 1, 0
    s_lshl_b32 s70, s69, s70
    s_mul_i32 s70, s70, 192
    s_lshl_b32 s67, s72, 8
    s_add_u32 s70, s70, s67
    s_mul_i32 s67, s3, 12288
    s_add_u32 s70, s70, s67
    s_add_u32 s70, s70, 266240
    s_cmp_ge_u32 s6, 24
    s_cbranch_scc1 L_rmr_37
    s_add_u32 s78, s3, 8
    s_add_u32 s79, s78, 1
    s_and_b32 s78, s78, 15
    s_lshl_b32 s78, s78, 13
    v_add_u32 v164, s78, v160
    v_add_u32 v165, s78, v161
    v_add_u32 v166, s78, v162
    v_add_u32 v167, s78, v163
    v_mul_u32_u24 v16, 272, v4
    v_lshl_add_u32 v16, v2, 4, v16
    v_add_u32 v11, s78, v16
    s_mov_b32 s67, 65536
    s_mul_i32 s77, s3, 272
    s_add_u32 s67, s67, s77
    v_add_u32 v12, s67, v13
    s_mov_b32 s80, 160000
L_lw_39:
    ds_read_b32 v16, v14 offset:0
    s_waitcnt lgkmcnt(0)
    v_cmp_le_i32 vcc, s79, v16
    s_sub_u32 s80, s80, 1
    s_cbranch_vccnz L_lwd_40
    s_nop 15
    s_nop 15
    s_nop 15
    s_cmp_lg_u32 s80, 0
    s_cbranch_scc1 L_lw_39
L_lwd_40:
L_lwe_41:
    ds_read_b64_tr_b16 v[64:65], v164 offset:0
    ds_read_b64_tr_b16 v[66:67], v164 offset:2048
    ds_read_b64_tr_b16 v[68:69], v164 offset:4096
    ds_read_b64_tr_b16 v[70:71], v164 offset:6144
    ds_read_b64_tr_b16 v[72:73], v165 offset:0
    ds_read_b64_tr_b16 v[74:75], v165 offset:2048
    ds_read_b64_tr_b16 v[76:77], v165 offset:4096
    ds_read_b64_tr_b16 v[78:79], v165 offset:6144
    ds_read_b64_tr_b16 v[80:81], v166 offset:0
    ds_read_b64_tr_b16 v[82:83], v166 offset:2048
    ds_read_b64_tr_b16 v[84:85], v166 offset:4096
    ds_read_b64_tr_b16 v[86:87], v166 offset:6144
    ds_read_b64_tr_b16 v[88:89], v167 offset:0
    ds_read_b64_tr_b16 v[90:91], v167 offset:2048
    ds_read_b64_tr_b16 v[92:93], v167 offset:4096
    ds_read_b64_tr_b16 v[94:95], v167 offset:6144
    s_waitcnt lgkmcnt(0)
    v_mfma_f32_16x16x32_bf16 v[32:35], v[64:67], v[100:103], 0
    v_mov_b32_dpp v104, v100 row_ror:8 row_mask:0xf bank_mask:0xf
    v_mfma_f32_16x16x32_bf16 v[36:39], v[72:75], v[100:103], 0
    v_mov_b32_dpp v105, v101 row_ror:8 row_mask:0xf bank_mask:0xf
    v_mfma_f32_16x16x32_bf16 v[40:43], v[80:83], v[100:103], 0
    v_mov_b32_dpp v106, v102 row_ror:8 row_mask:0xf bank_mask:0xf
    v_mfma_f32_16x16x32_bf16 v[44:47], v[88:91], v[100:103], 0
    v_mov_b32_dpp v107, v103 row_ror:8 row_mask:0xf bank_mask:0xf
    s_nop 1
    v_mfma_f32_16x16x32_bf16 v[32:35], v[68:71], v[104:107], v[32:35]
    v_mfma_f32_16x16x32_bf16 v[36:39], v[76:79], v[104:107], v[36:39]
    v_mfma_f32_16x16x32_bf16 v[40:43], v[84:87], v[104:107], v[40:43]
    v_mfma_f32_16x16x32_bf16 v[44:47], v[92:95], v[104:107], v[44:47]
    s_mov_b64 exec, s[84:85]
    s_nop 3
    ds_write_b128 v11, v[32:35] offset:0
    ds_write_b128 v11, v[36:39] offset:64
    ds_write_b128 v11, v[40:43] offset:128
    ds_write_b128 v11, v[44:47] offset:192
    s_mov_b64 exec, 1
    ds_add_u32 v14, v15 offset:104
    s_mov_b64 exec, -1
L_nomm_42:
    ds_read_b32 v24, v14 offset:104
    ds_read2st64_b32 v[16:17], v12 offset0:0 offset1:32
    ds_read2st64_b32 v[18:19], v12 offset0:64 offset1:96
    ds_read2st64_b32 v[20:21], v12 offset0:128 offset1:160
    ds_read2st64_b32 v[22:23], v12 offset0:192 offset1:224
    s_waitcnt lgkmcnt(4)
    v_cmp_le_i32 vcc, 8, v24
    s_cbranch_vccnz L_lwe_45
    s_mov_b32 s80, 160000
L_lw_43:
    ds_read_b32 v24, v14 offset:104
    s_waitcnt lgkmcnt(0)
    v_cmp_le_i32 vcc, 8, v24
    s_sub_u32 s80, s80, 1
    s_cbranch_vccnz L_lwd_44
    s_nop 15
    s_nop 15
    s_nop 15
    s_cmp_lg_u32 s80, 0
    s_cbranch_scc1 L_lw_43
L_lwd_44:
    ds_read2st64_b32 v[16:17], v12 offset0:0 offset1:32
    ds_read2st64_b32 v[18:19], v12 offset0:64 offset1:96
    ds_read2st64_b32 v[20:21], v12 offset0:128 offset1:160
    ds_read2st64_b32 v[22:23], v12 offset0:192 offset1:224
L_lwe_45:
    s_waitcnt lgkmcnt(3)
    v_add_f32 v16, v16, v17
    s_waitcnt lgkmcnt(2)
    v_add_f32 v16, v16, v18
    v_add_f32 v16, v16, v19
    s_waitcnt lgkmcnt(1)
    v_add_f32 v16, v16, v20
    v_add_f32 v16, v16, v21
    s_waitcnt lgkmcnt(0)
    v_add_f32 v16, v16, v22
    v_add_f32 v16, v16, v23
    v_bfi_b32 v16, v6, s4, v16
    buffer_store_dword v16, v13, s[52:55], s70 offen sc1
    v_add_u32 v16, v13, v14
    s_mov_b64 exec, 0xff
    ds_add_u32 v16, v15 offset:36
    s_mov_b64 exec, -1
    s_branch L_rme_38
L_rmr_37:
    s_add_u32 s78, s3, 12
    s_add_u32 s79, s78, 1
    s_and_b32 s78, s78, 15
    s_lshl_b32 s78, s78, 13
    v_mul_u32_u24 v16, 272, v4
    v_lshl_add_u32 v16, v2, 4, v16
    v_add_u32 v11, s78, v16
    s_mov_b32 s67, 98304
    s_mul_i32 s77, s3, 272
    s_add_u32 s67, s67, s77
    v_add_u32 v12, s67, v13
    s_cmp_ge_u32 s3, 4
    s_cbranch_scc1 L_rms_46
    s_add_u32 s78, s3, 12
    s_add_u32 s79, s78, 1
    s_and_b32 s78, s78, 15
    s_lshl_b32 s78, s78, 13
    v_add_u32 v164, s78, v160
    v_add_u32 v165, s78, v161
    v_add_u32 v166, s78, v162
    v_add_u32 v167, s78, v163
    s_mov_b32 s80, 160000
L_lw_47:
    ds_read_b32 v16, v14 offset:0
    s_waitcnt lgkmcnt(0)
    v_cmp_le_i32 vcc, s79, v16
    s_sub_u32 s80, s80, 1
    s_cbranch_vccnz L_lwd_48
    s_nop 15
    s_nop 15
    s_nop 15
    s_cmp_lg_u32 s80, 0
    s_cbranch_scc1 L_lw_47
L_lwd_48:
L_lwe_49:
    ds_read_b64_tr_b16 v[64:65], v164 offset:0
    ds_read_b64_tr_b16 v[66:67], v164 offset:2048
    ds_read_b64_tr_b16 v[68:69], v164 offset:4096
    ds_read_b64_tr_b16 v[70:71], v164 offset:6144
    ds_read_b64_tr_b16 v[72:73], v165 offset:0
    ds_read_b64_tr_b16 v[74:75], v165 offset:2048
    ds_read_b64_tr_b16 v[76:77], v165 offset:4096
    ds_read_b64_tr_b16 v[78:79], v165 offset:6144
    ds_read_b64_tr_b16 v[80:81], v166 offset:0
    ds_read_b64_tr_b16 v[82:83], v166 offset:2048
    ds_read_b64_tr_b16 v[84:85], v166 offset:4096
    ds_read_b64_tr_b16 v[86:87], v166 offset:6144
    ds_read_b64_tr_b16 v[88:89], v167 offset:0
    ds_read_b64_tr_b16 v[90:91], v167 offset:2048
    ds_read_b64_tr_b16 v[92:93], v167 offset:4096
    ds_read_b64_tr_b16 v[94:95], v167 offset:6144
    s_waitcnt lgkmcnt(0)
L_rms_46:
    s_cmp_ge_u32 s3, 4
    s_cbranch_scc1 L_nomm_50
    v_mfma_f32_16x16x32_bf16 v[32:35], v[64:67], v[100:103], 0
    v_mov_b32_dpp v104, v100 row_ror:8 row_mask:0xf bank_mask:0xf
    v_mfma_f32_16x16x32_bf16 v[36:39], v[72:75], v[100:103], 0
    v_mov_b32_dpp v105, v101 row_ror:8 row_mask:0xf bank_mask:0xf
    v_mfma_f32_16x16x32_bf16 v[40:43], v[80:83], v[100:103], 0
    v_mov_b32_dpp v106, v102 row_ror:8 row_mask:0xf bank_mask:0xf
    v_mfma_f32_16x16x32_bf16 v[44:47], v[88:91], v[100:103], 0
    v_mov_b32_dpp v107, v103 row_ror:8 row_mask:0xf bank_mask:0xf
    s_nop 1
    v_mfma_f32_16x16x32_bf16 v[32:35], v[68:71], v[104:107], v[32:35]
    v_mfma_f32_16x16x32_bf16 v[36:39], v[76:79], v[104:107], v[36:39]
    v_mfma_f32_16x16x32_bf16 v[40:43], v[84:87], v[104:107], v[40:43]
    v_mfma_f32_16x16x32_bf16 v[44:47], v[92:95], v[104:107], v[44:47]
    s_mov_b64 exec, s[84:85]
    s_nop 3
    ds_write_b128 v11, v[32:35] offset:0
    ds_write_b128 v11, v[36:39] offset:64
    ds_write_b128 v11, v[40:43] offset:128
    ds_write_b128 v11, v[44:47] offset:192
    s_mov_b64 exec, 1
    ds_add_u32 v14, v15 offset:104
    s_mov_b64 exec, -1
L_nomm_50:
    ds_read_b32 v24, v14 offset:104
    ds_read2st64_b32 v[16:17], v12 offset0:0 offset1:32
    ds_read2st64_b32 v[18:19], v12 offset0:64 offset1:96
    s_waitcnt lgkmcnt(2)
    v_cmp_le_i32 vcc, 4, v24
    s_cbranch_vccnz L_lwe_53
    s_mov_b32 s80, 160000
L_lw_51:
    ds_read_b32 v24, v14 offset:104
    s_waitcnt lgkmcnt(0)
    v_cmp_le_i32 vcc, 4, v24
    s_sub_u32 s80, s80, 1
    s_cbranch_vccnz L_lwd_52
    s_nop 15
    s_nop 15
    s_nop 15
    s_cmp_lg_u32 s80, 0
    s_cbranch_scc1 L_lw_51
L_lwd_52:
    ds_read2st64_b32 v[16:17], v12 offset0:0 offset1:32
    ds_read2st64_b32 v[18:19], v12 offset0:64 offset1:96
L_lwe_53:
    s_waitcnt lgkmcnt(1)
    v_add_f32 v16, v16, v17
    s_waitcnt lgkmcnt(0)
    v_add_f32 v16, v16, v18
    v_add_f32 v16, v16, v19
    v_bfi_b32 v16, v6, s4, v16
    buffer_store_dword v16, v13, s[52:55], s70 offen sc1
    v_add_u32 v16, v13, v14
    s_mov_b64 exec, 0xf
    ds_add_u32 v16, v15 offset:52
    s_mov_b64 exec, -1
L_rme_38:
    s_sub_u32 s68, s6, 16
    s_cmp_eq_u32 s6, 19
    s_cselect_b32 s68, 9, s68
    s_cmp_eq_u32 s6, 25
    s_cselect_b32 s68, 3, s68
    s_lshl_b32 s70, s5, 15
    s_lshl_b32 s67, s68, 8
    s_add_u32 s70, s70, s67
    s_lshl_b32 s67, s3, 12
    s_add_u32 s70, s70, s67
    s_add_u32 s70, s70, 2236416
    s_add_u32 s69, s70, 4194304
    v_lshlrev_b32 v8, 4, v1
    s_lshl_b32 s72, s5, 11
    s_lshl_b32 s67, s3, 16
    s_add_u32 s72, s72, s67
    s_add_u32 s72, s72, 1708032
    s_add_u32 s73, s72, 16384
    s_add_u32 s74, s72, 32768
    s_add_u32 s75, s72, 49152
    v_lshlrev_b32 v9, 4, v4
    s_lshr_b32 s71, s5, 1
    s_lshl_b32 s71, s71, 10
    s_lshl_b32 s67, s3, 7
    s_add_u32 s71, s71, s67
    s_add_u32 s71, s71, 2232320
    v_bfe_u32 v16, v0, 2, 1
    v_lshl_add_u32 v16, v2, 1, v16
    v_lshl_add_u32 v29, v16, 9, v14
    v_xor_b32 v16, s3, v16
    v_lshl_add_u32 v29, v16, 4, v29
    v_and_b32 v16, 1, v0
    v_lshl_add_u32 v29, v16, 8, v29
    v_lshl_add_u32 v29, v5, 7, v29
    v_bfe_u32 v16, v0, 1, 1
    v_lshl_add_u32 v29, v16, 3, v29
    s_and_b32 s67, s3, 3
    s_lshl_b32 s67, s67, 1
    v_xor_b32 v16, v5, v4
    v_xor_b32 v16, s67, v16
    v_lshl_add_u32 v30, v16, 4, v14
    v_lshl_add_u32 v30, v2, 7, v30
    v_lshl_add_u32 v30, v5, 9, v30
    s_lshl_b32 s67, s3, 10
    v_add_u32 v30, s67, v30
    v_and_b32 v16, 31, v1
    v_lshlrev_b32 v16, 4, v16
    v_lshrrev_b32 v17, 5, v1
    v_mul_u32_u24 v112, 98304, v17
    v_add_u32 v112, v112, v16
    v_add_u32 v113, 196608, v112
    s_and_b32 s97, s6, 7
    s_lshl_b32 s67, s3, 9
    s_mul_i32 s94, s97, 12288
    s_add_u32 s94, s94, s67
    s_add_u32 s94, s94, 266240
    s_add_u32 s95, s94, 4096
    s_add_u32 s96, s94, 8192
    v_not_b32 v96, s4
    s_mov_b32 s36, 0x18490c28
    s_mov_b32 s37, 0xe88a
    s_lshl_b32 s67, s3, 1
    s_lshr_b64 s[36:37], s[36:37], s67
    s_bitcmp1_b64 s[36:37], 0
    s_cselect_b32 s30, 0xffff, 0
    s_bitcmp1_b64 s[36:37], 1
    s_cselect_b32 s67, 0xffff0000, 0
    s_or_b32 s30, s30, s67
    s_mov_b32 s31, s30
    s_bitcmp1_b64 s[36:37], 16
    s_cselect_b32 s32, 0xffff, 0
    s_bitcmp1_b64 s[36:37], 17
    s_cselect_b32 s67, 0xffff0000, 0
    s_or_b32 s32, s32, s67
    s_mov_b32 s33, s32
    s_bitcmp1_b64 s[36:37], 32
    s_cselect_b32 s34, 0xffff, 0
    s_bitcmp1_b64 s[36:37], 33
    s_cselect_b32 s67, 0xffff0000, 0
    s_or_b32 s34, s34, s67
    s_mov_b32 s35, s34
    v_mov_b32 v116, s4
    v_mov_b32 v117, s4
    v_mov_b32 v118, s4
    v_mov_b32 v119, s4
    v_mov_b32 v120, s4
    v_mov_b32 v121, s4
    v_mov_b32 v122, s4
    v_mov_b32 v123, s4
    v_mov_b32 v124, s4
    v_mov_b32 v125, s4
    v_mov_b32 v126, s4
    v_mov_b32 v127, s4
    s_add_u32 s78, s3, 16
    s_add_u32 s79, s78, 1
    s_and_b32 s78, s78, 15
    s_lshl_b32 s78, s78, 13
    v_add_u32 v164, s78, v160
    v_add_u32 v165, s78, v161
    v_add_u32 v166, s78, v162
    v_add_u32 v167, s78, v163
    v_mul_u32_u24 v16, 272, v4
    v_lshl_add_u32 v16, v2, 4, v16
    v_add_u32 v11, s78, v16
    s_mov_b32 s67, 0
    s_mul_i32 s77, s3, 272
    s_add_u32 s67, s67, s77
    v_add_u32 v12, s67, v13
    s_mov_b32 s77, 0
    s_mov_b32 s80, 20007
L_poll_55:
    buffer_load_dwordx4 v[32:35], v9, s[52:55], s71 offen sc1
    s_cmp_lg_u32 s77, 0
    s_cbranch_scc1 L_hk_57
    ds_read_b32 v16, v14 offset:0
    s_waitcnt lgkmcnt(0)
    v_cmp_le_i32 vcc, s79, v16
    s_cbranch_vccz L_hk_57
    s_mov_b64 exec, -1
    ds_read_b64_tr_b16 v[64:65], v164 offset:0
    ds_read_b64_tr_b16 v[66:67], v164 offset:2048
    ds_read_b64_tr_b16 v[68:69], v164 offset:4096
    ds_read_b64_tr_b16 v[70:71], v164 offset:6144
    ds_read_b64_tr_b16 v[72:73], v165 offset:0
    ds_read_b64_tr_b16 v[74:75], v165 offset:2048
    ds_read_b64_tr_b16 v[76:77], v165 offset:4096
    ds_read_b64_tr_b16 v[78:79], v165 offset:6144
    ds_read_b64_tr_b16 v[80:81], v166 offset:0
    ds_read_b64_tr_b16 v[82:83], v166 offset:2048
    ds_read_b64_tr_b16 v[84:85], v166 offset:4096
    ds_read_b64_tr_b16 v[86:87], v166 offset:6144
    ds_read_b64_tr_b16 v[88:89], v167 offset:0
    ds_read_b64_tr_b16 v[90:91], v167 offset:2048
    ds_read_b64_tr_b16 v[92:93], v167 offset:4096
    ds_read_b64_tr_b16 v[94:95], v167 offset:6144
    s_mov_b32 exec_lo, 0xffffffff
    s_mov_b32 exec_hi, 0xffffffff
    s_mov_b32 s77, 1
L_hk_57:
    s_waitcnt vmcnt(0)
    v_xor_b32 v24, s4, v32
    v_bitop3_b32 v24, v33, v24, s4 bitop3:0xde
    v_bitop3_b32 v24, v34, v24, s4 bitop3:0xde
    v_bitop3_b32 v24, v35, v24, s4 bitop3:0xde
    v_and_b32 v24, v6, v24
    v_cmp_ne_u32 vcc, 0, v24
    s_sub_u32 s80, s80, 1
    s_cbranch_vccz L_pdone_56
    s_cmp_lg_u32 s80, 0
    s_cbranch_scc1 L_poll_55
L_pdone_56:
L_p3g:
    buffer_load_dwordx4 v[128:131], v8, s[52:55], s72 offen offset:0
    buffer_load_dwordx4 v[132:135], v8, s[52:55], s72 offen offset:1024
    buffer_load_dwordx4 v[136:139], v8, s[52:55], s73 offen offset:0
    buffer_load_dwordx4 v[140:143], v8, s[52:55], s73 offen offset:1024
    buffer_load_dwordx4 v[144:147], v8, s[52:55], s74 offen offset:0
    buffer_load_dwordx4 v[148:151], v8, s[52:55], s74 offen offset:1024
    buffer_load_dwordx4 v[152:155], v8, s[52:55], s75 offen offset:0
    buffer_load_dwordx4 v[156:159], v8, s[52:55], s75 offen offset:1024
    v_max3_f32 v36, v32, v33, v34
    v_max_f32 v36, v36, v35
    v_sub_f32 v40, v32, v36
    v_sub_f32 v41, v33, v36
    v_sub_f32 v42, v34, v36
    v_sub_f32 v43, v35, v36
    v_exp_f32 v40, v40
    v_exp_f32 v41, v41
    v_exp_f32 v42, v42
    v_exp_f32 v43, v43
    v_add_f32 v36, v40, v41
    v_add_f32 v37, v42, v43
    v_add_f32 v36, v36, v37
    v_rcp_f32 v36, v36
    s_nop 0
    v_mul_f32 v40, v40, v36
    v_mul_f32 v41, v41, v36
    v_mul_f32 v42, v42, v36
    v_mul_f32 v43, v43, v36
    s_waitcnt vmcnt(7)
    v_xor_b32 v24, s4, v128
    v_bitop3_b32 v24, v129, v24, s4 bitop3:0xde
    v_bitop3_b32 v24, v130, v24, s4 bitop3:0xde
    v_bitop3_b32 v24, v131, v24, s4 bitop3:0xde
    s_waitcnt vmcnt(6)
    v_bitop3_b32 v24, v132, v24, s4 bitop3:0xde
    v_bitop3_b32 v24, v133, v24, s4 bitop3:0xde
    v_bitop3_b32 v24, v134, v24, s4 bitop3:0xde
    v_bitop3_b32 v24, v135, v24, s4 bitop3:0xde
    s_waitcnt vmcnt(5)
    v_bitop3_b32 v24, v136, v24, s4 bitop3:0xde
    v_bitop3_b32 v24, v137, v24, s4 bitop3:0xde
    v_bitop3_b32 v24, v138, v24, s4 bitop3:0xde
    v_bitop3_b32 v24, v139, v24, s4 bitop3:0xde
    s_waitcnt vmcnt(4)
    v_bitop3_b32 v24, v140, v24, s4 bitop3:0xde
    v_bitop3_b32 v24, v141, v24, s4 bitop3:0xde
    v_bitop3_b32 v24, v142, v24, s4 bitop3:0xde
    v_bitop3_b32 v24, v143, v24, s4 bitop3:0xde
    s_waitcnt vmcnt(3)
    v_bitop3_b32 v24, v144, v24, s4 bitop3:0xde
    v_bitop3_b32 v24, v145, v24, s4 bitop3:0xde
    v_bitop3_b32 v24, v146, v24, s4 bitop3:0xde
    v_bitop3_b32 v24, v147, v24, s4 bitop3:0xde
    s_waitcnt vmcnt(2)
    v_bitop3_b32 v24, v148, v24, s4 bitop3:0xde
    v_bitop3_b32 v24, v149, v24, s4 bitop3:0xde
    v_bitop3_b32 v24, v150, v24, s4 bitop3:0xde
    v_bitop3_b32 v24, v151, v24, s4 bitop3:0xde
    s_waitcnt vmcnt(1)
    v_bitop3_b32 v24, v152, v24, s4 bitop3:0xde
    v_bitop3_b32 v24, v153, v24, s4 bitop3:0xde
    v_bitop3_b32 v24, v154, v24, s4 bitop3:0xde
    v_bitop3_b32 v24, v155, v24, s4 bitop3:0xde
    s_waitcnt vmcnt(0)
    v_bitop3_b32 v24, v156, v24, s4 bitop3:0xde
    v_bitop3_b32 v24, v157, v24, s4 bitop3:0xde
    v_bitop3_b32 v24, v158, v24, s4 bitop3:0xde
    v_bitop3_b32 v24, v159, v24, s4 bitop3:0xde
    v_and_b32 v24, v6, v24
    v_cmp_ne_u32 vcc, 0, v24
    s_mov_b32 s80, 20007
    s_cbranch_vccz L_pdone_59
L_poll_58:
    buffer_load_dwordx4 v[128:131], v8, s[52:55], s72 offen offset:0 sc1
    buffer_load_dwordx4 v[132:135], v8, s[52:55], s72 offen offset:1024 sc1
    buffer_load_dwordx4 v[136:139], v8, s[52:55], s73 offen offset:0 sc1
    buffer_load_dwordx4 v[140:143], v8, s[52:55], s73 offen offset:1024 sc1
    buffer_load_dwordx4 v[144:147], v8, s[52:55], s74 offen offset:0 sc1
    buffer_load_dwordx4 v[148:151], v8, s[52:55], s74 offen offset:1024 sc1
    buffer_load_dwordx4 v[152:155], v8, s[52:55], s75 offen offset:0 sc1
    buffer_load_dwordx4 v[156:159], v8, s[52:55], s75 offen offset:1024 sc1
    s_waitcnt vmcnt(7)
    v_xor_b32 v24, s4, v128
    v_bitop3_b32 v24, v129, v24, s4 bitop3:0xde
    v_bitop3_b32 v24, v130, v24, s4 bitop3:0xde
    v_bitop3_b32 v24, v131, v24, s4 bitop3:0xde
    s_waitcnt vmcnt(6)
    v_bitop3_b32 v24, v132, v24, s4 bitop3:0xde
    v_bitop3_b32 v24, v133, v24, s4 bitop3:0xde
    v_bitop3_b32 v24, v134, v24, s4 bitop3:0xde
    v_bitop3_b32 v24, v135, v24, s4 bitop3:0xde
    s_waitcnt vmcnt(5)
    v_bitop3_b32 v24, v136, v24, s4 bitop3:0xde
    v_bitop3_b32 v24, v137, v24, s4 bitop3:0xde
    v_bitop3_b32 v24, v138, v24, s4 bitop3:0xde
    v_bitop3_b32 v24, v139, v24, s4 bitop3:0xde
    s_waitcnt vmcnt(4)
    v_bitop3_b32 v24, v140, v24, s4 bitop3:0xde
    v_bitop3_b32 v24, v141, v24, s4 bitop3:0xde
    v_bitop3_b32 v24, v142, v24, s4 bitop3:0xde
    v_bitop3_b32 v24, v143, v24, s4 bitop3:0xde
    s_waitcnt vmcnt(3)
    v_bitop3_b32 v24, v144, v24, s4 bitop3:0xde
    v_bitop3_b32 v24, v145, v24, s4 bitop3:0xde
    v_bitop3_b32 v24, v146, v24, s4 bitop3:0xde
    v_bitop3_b32 v24, v147, v24, s4 bitop3:0xde
    s_waitcnt vmcnt(2)
    v_bitop3_b32 v24, v148, v24, s4 bitop3:0xde
    v_bitop3_b32 v24, v149, v24, s4 bitop3:0xde
    v_bitop3_b32 v24, v150, v24, s4 bitop3:0xde
    v_bitop3_b32 v24, v151, v24, s4 bitop3:0xde
    s_waitcnt vmcnt(1)
    v_bitop3_b32 v24, v152, v24, s4 bitop3:0xde
    v_bitop3_b32 v24, v153, v24, s4 bitop3:0xde
    v_bitop3_b32 v24, v154, v24, s4 bitop3:0xde
    v_bitop3_b32 v24, v155, v24, s4 bitop3:0xde
    s_waitcnt vmcnt(0)
    v_bitop3_b32 v24, v156, v24, s4 bitop3:0xde
    v_bitop3_b32 v24, v157, v24, s4 bitop3:0xde
    v_bitop3_b32 v24, v158, v24, s4 bitop3:0xde
    v_bitop3_b32 v24, v159, v24, s4 bitop3:0xde
    v_and_b32 v24, v6, v24
    v_cmp_ne_u32 vcc, 0, v24
    s_sub_u32 s80, s80, 1
    s_cbranch_vccz L_pdone_59
    s_cmp_lg_u32 s80, 0
    s_cbranch_scc1 L_poll_58
L_pdone_59:
    v_mul_f32 v128, v40, v128
    v_mul_f32 v129, v40, v129
    v_mul_f32 v130, v40, v130
    v_mul_f32 v131, v40, v131
    v_mul_f32 v132, v40, v132
    v_mul_f32 v133, v40, v133
    v_mul_f32 v134, v40, v134
    v_mul_f32 v135, v40, v135
    v_fmac_f32 v128, v41, v136
    v_fmac_f32 v129, v41, v137
    v_fmac_f32 v130, v41, v138
    v_fmac_f32 v131, v41, v139
    v_fmac_f32 v132, v41, v140
    v_fmac_f32 v133, v41, v141
    v_fmac_f32 v134, v41, v142
    v_fmac_f32 v135, v41, v143
    v_fmac_f32 v128, v42, v144
    v_fmac_f32 v129, v42, v145
    v_fmac_f32 v130, v42, v146
    v_fmac_f32 v131, v42, v147
    v_fmac_f32 v132, v42, v148
    v_fmac_f32 v133, v42, v149
    v_fmac_f32 v134, v42, v150
    v_fmac_f32 v135, v42, v151
    v_fmac_f32 v128, v43, v152
    v_fmac_f32 v129, v43, v153
    v_fmac_f32 v130, v43, v154
    v_fmac_f32 v131, v43, v155
    v_fmac_f32 v132, v43, v156
    v_fmac_f32 v133, v43, v157
    v_fmac_f32 v134, v43, v158
    v_fmac_f32 v135, v43, v159
    v_cvt_pk_bf16_f32 v16, v128, v129
    v_cvt_pk_bf16_f32 v17, v130, v131
    v_cvt_pk_bf16_f32 v18, v132, v133
    v_cvt_pk_bf16_f32 v19, v134, v135
    ds_write_b64 v29, v[16:17] offset:2560
    ds_write_b64 v29, v[18:19] offset:6656
    s_mov_b64 exec, 1
    ds_add_u32 v14, v15 offset:144
    s_mov_b64 exec, -1
    s_cmp_lg_u32 s77, 0
    s_cbranch_scc1 L_lp_60
    ds_read_b32 v24, v14 offset:0
    ds_read_b64_tr_b16 v[64:65], v164 offset:0
    ds_read_b64_tr_b16 v[66:67], v164 offset:2048
    ds_read_b64_tr_b16 v[68:69], v164 offset:4096
    ds_read_b64_tr_b16 v[70:71], v164 offset:6144
    ds_read_b64_tr_b16 v[72:73], v165 offset:0
    ds_read_b64_tr_b16 v[74:75], v165 offset:2048
    ds_read_b64_tr_b16 v[76:77], v165 offset:4096
    ds_read_b64_tr_b16 v[78:79], v165 offset:6144
    ds_read_b64_tr_b16 v[80:81], v166 offset:0
    ds_read_b64_tr_b16 v[82:83], v166 offset:2048
    ds_read_b64_tr_b16 v[84:85], v166 offset:4096
    ds_read_b64_tr_b16 v[86:87], v166 offset:6144
    ds_read_b64_tr_b16 v[88:89], v167 offset:0
    ds_read_b64_tr_b16 v[90:91], v167 offset:2048
    ds_read_b64_tr_b16 v[92:93], v167 offset:4096
    ds_read_b64_tr_b16 v[94:95], v167 offset:6144
    s_waitcnt lgkmcnt(15)
    v_cmp_le_i32 vcc, s79, v24
    s_cbranch_vccnz L_lwe_63
    s_mov_b32 s80, 160000
L_lw_61:
    ds_read_b32 v24, v14 offset:0
    s_waitcnt lgkmcnt(0)
    v_cmp_le_i32 vcc, s79, v24
    s_sub_u32 s80, s80, 1
    s_cbranch_vccnz L_lwd_62
    s_cmp_lg_u32 s80, 0
    s_cbranch_scc1 L_lw_61
L_lwd_62:
    ds_read_b64_tr_b16 v[64:65], v164 offset:0
    ds_read_b64_tr_b16 v[66:67], v164 offset:2048
    ds_read_b64_tr_b16 v[68:69], v164 offset:4096
    ds_read_b64_tr_b16 v[70:71], v164 offset:6144
    ds_read_b64_tr_b16 v[72:73], v165 offset:0
    ds_read_b64_tr_b16 v[74:75], v165 offset:2048
    ds_read_b64_tr_b16 v[76:77], v165 offset:4096
    ds_read_b64_tr_b16 v[78:79], v165 offset:6144
    ds_read_b64_tr_b16 v[80:81], v166 offset:0
    ds_read_b64_tr_b16 v[82:83], v166 offset:2048
    ds_read_b64_tr_b16 v[84:85], v166 offset:4096
    ds_read_b64_tr_b16 v[86:87], v166 offset:6144
    ds_read_b64_tr_b16 v[88:89], v167 offset:0
    ds_read_b64_tr_b16 v[90:91], v167 offset:2048
    ds_read_b64_tr_b16 v[92:93], v167 offset:4096
    ds_read_b64_tr_b16 v[94:95], v167 offset:6144
L_lwe_63:
L_lp_60:
    s_mov_b32 s80, 160000
L_lw_64:
    ds_read_b32 v24, v14 offset:144
    ds_read_b128 v[48:51], v30 offset:2560
    s_sub_u32 s80, s80, 1
    s_cbranch_scc1 L_lwe_66
    s_waitcnt lgkmcnt(1)
    v_cmp_le_i32 vcc, 8, v24
    s_cbranch_vccz L_lw_64
L_lwe_66:
    s_cmp_lt_u32 s6, 24
    s_cbranch_scc1 L_nomod_54
    s_mov_b64 exec, s[30:31]
    s_cbranch_execz L_mq_67
    buffer_load_dwordx4 v[116:119], v113, s[52:55], s94 offen sc1
L_mq_67:
    s_mov_b64 exec, s[32:33]
    s_cbranch_execz L_mq_68
    buffer_load_dwordx4 v[120:123], v113, s[52:55], s95 offen sc1
L_mq_68:
    s_mov_b64 exec, s[34:35]
    s_cbranch_execz L_mq_69
    buffer_load_dwordx4 v[124:127], v113, s[52:55], s96 offen sc1
L_mq_69:
    s_mov_b64 exec, -1
    buffer_load_dwordx4 v[96:99], v112, s[52:55], s94 offen sc1
    buffer_load_dwordx4 v[100:103], v112, s[52:55], s95 offen sc1
    buffer_load_dwordx4 v[104:107], v112, s[52:55], s96 offen sc1
L_nomod_54:
    s_waitcnt lgkmcnt(0)
    v_mfma_f32_16x16x32_bf16 v[32:35], v[64:67], v[48:51], 0
    v_mov_b32_dpp v52, v48 row_ror:8 row_mask:0xf bank_mask:0xf
    v_mfma_f32_16x16x32_bf16 v[36:39], v[72:75], v[48:51], 0
    v_mov_b32_dpp v53, v49 row_ror:8 row_mask:0xf bank_mask:0xf
    v_mfma_f32_16x16x32_bf16 v[40:43], v[80:83], v[48:51], 0
    v_mov_b32_dpp v54, v50 row_ror:8 row_mask:0xf bank_mask:0xf
    v_mfma_f32_16x16x32_bf16 v[44:47], v[88:91], v[48:51], 0
    v_mov_b32_dpp v55, v51 row_ror:8 row_mask:0xf bank_mask:0xf
    s_nop 1
    v_mfma_f32_16x16x32_bf16 v[32:35], v[68:71], v[52:55], v[32:35]
    v_mfma_f32_16x16x32_bf16 v[36:39], v[76:79], v[52:55], v[36:39]
    v_mfma_f32_16x16x32_bf16 v[40:43], v[84:87], v[52:55], v[40:43]
    v_mfma_f32_16x16x32_bf16 v[44:47], v[92:95], v[52:55], v[44:47]
    s_mov_b64 exec, s[84:85]
    s_nop 3
    ds_write_b128 v11, v[32:35] offset:0
    ds_write_b128 v11, v[36:39] offset:64
    ds_write_b128 v11, v[40:43] offset:128
    ds_write_b128 v11, v[44:47] offset:192
    s_mov_b64 exec, 1
    ds_add_u32 v14, v15 offset:108
    s_mov_b64 exec, -1
L_nomm_70:
    s_mov_b32 s80, 160000
L_lw_71:
    ds_read_b32 v24, v14 offset:108
    ds_read2st64_b32 v[16:17], v12 offset0:0 offset1:32
    ds_read2st64_b32 v[18:19], v12 offset0:64 offset1:96
    ds_read2st64_b32 v[20:21], v12 offset0:128 offset1:160
    ds_read2st64_b32 v[22:23], v12 offset0:192 offset1:224
    s_sub_u32 s80, s80, 1
    s_cbranch_scc1 L_lwe_73
    s_waitcnt lgkmcnt(4)
    v_cmp_le_i32 vcc, 8, v24
    s_cbranch_vccz L_lw_71
L_lwe_73:
    s_waitcnt lgkmcnt(3)
    v_add_f32 v16, v16, v17
    s_waitcnt lgkmcnt(2)
    v_add_f32 v16, v16, v18
    v_add_f32 v16, v16, v19
    s_waitcnt lgkmcnt(1)
    v_add_f32 v16, v16, v20
    v_add_f32 v16, v16, v21
    s_waitcnt lgkmcnt(0)
    v_add_f32 v16, v16, v22
    v_add_f32 v16, v16, v23
    v_bfi_b32 v16, v6, s4, v16
    buffer_store_dword v16, v13, s[52:55], s69 offen
    buffer_store_dword v16, v13, s[52:55], s70 offen sc1
    s_mov_b64 exec, 1
    ds_add_u32 v14, v15 offset:112
    s_mov_b64 exec, -1
    s_cmp_lt_u32 s6, 24
    s_cbranch_scc1 L_nor3
    s_sub_u32 s69, s6, 24
    v_and_b32 v8, 31, v1
    v_lshlrev_b32 v9, 4, v8
    s_lshl_b32 s67, s3, 9
    s_lshl_b32 s71, s69, 12
    s_add_u32 s71, s71, s67
    v_lshrrev_b32 v16, 1, v9
    s_lshr_b32 s67, s71, 1
    buffer_load_dwordx2 v[28:29], v16, s[8:11], s67 offen
    v_lshrrev_b32 v16, 5, v1
    v_sub_u32 v69, 1, v16
    v_add_u32 v16, s5, v16
    v_add_u32 v17, 0, v16
    v_and_b32 v17, 7, v17
    v_lshlrev_b32 v17, 15, v17
    v_lshl_add_u32 v68, v8, 4, v17
    v_add_u32 v17, 2, v16
    v_and_b32 v17, 7, v17
    v_lshlrev_b32 v17, 15, v17
    v_lshl_add_u32 v65, v8, 4, v17
    v_add_u32 v17, 4, v16
    v_and_b32 v17, 7, v17
    v_lshlrev_b32 v17, 15, v17
    v_lshl_add_u32 v66, v8, 4, v17
    v_add_u32 v17, 6, v16
    v_and_b32 v17, 7, v17
    v_lshlrev_b32 v17, 15, v17
    v_lshl_add_u32 v67, v8, 4, v17
    v_lshl_add_u32 v64, v69, 22, v68
    s_add_u32 s77, s71, 2236416
    s_lshl_b32 s67, s5, 15
    s_add_u32 s71, s71, s67
    s_lshl_b32 s70, s5, 3
    s_add_u32 s70, s70, s69
    s_mul_i32 s70, s70, 4224
    s_lshl_b32 s67, s3, 9
    s_add_u32 s70, s70, s67
    s_add_u32 s70, s70, 3022848
    s_add_u32 s76, s70, 4194304
    s_add_u32 s71, s71, 2498560
    s_lshl_b32 s67, s3, 3
    v_add_u32 v10, s67, v14
    buffer_load_dwordx4 v[32:35], v64, s[52:55], s77 offen sc1
    buffer_load_dwordx4 v[36:39], v65, s[52:55], s77 offen sc1
    buffer_load_dwordx4 v[40:43], v66, s[52:55], s77 offen sc1
    buffer_load_dwordx4 v[44:47], v67, s[52:55], s77 offen sc1
    s_waitcnt vmcnt(7)
    v_xor_b32 v25, s4, v96
    v_bitop3_b32 v25, v97, v25, s4 bitop3:0xde
    v_bitop3_b32 v25, v98, v25, s4 bitop3:0xde
    v_bitop3_b32 v25, v99, v25, s4 bitop3:0xde
    v_bitop3_b32 v25, v100, v25, s4 bitop3:0xde
    v_bitop3_b32 v25, v101, v25, s4 bitop3:0xde
    v_bitop3_b32 v25, v102, v25, s4 bitop3:0xde
    v_bitop3_b32 v25, v103, v25, s4 bitop3:0xde
    v_bitop3_b32 v25, v104, v25, s4 bitop3:0xde
    v_bitop3_b32 v25, v105, v25, s4 bitop3:0xde
    v_bitop3_b32 v25, v106, v25, s4 bitop3:0xde
    v_bitop3_b32 v25, v107, v25, s4 bitop3:0xde
    v_bitop3_b32 v25, v116, v25, s4 bitop3:0xde
    v_bitop3_b32 v25, v117, v25, s4 bitop3:0xde
    v_bitop3_b32 v25, v118, v25, s4 bitop3:0xde
    v_bitop3_b32 v25, v119, v25, s4 bitop3:0xde
    v_bitop3_b32 v25, v120, v25, s4 bitop3:0xde
    v_bitop3_b32 v25, v121, v25, s4 bitop3:0xde
    v_bitop3_b32 v25, v122, v25, s4 bitop3:0xde
    v_bitop3_b32 v25, v123, v25, s4 bitop3:0xde
    v_bitop3_b32 v25, v124, v25, s4 bitop3:0xde
    v_bitop3_b32 v25, v125, v25, s4 bitop3:0xde
    v_bitop3_b32 v25, v126, v25, s4 bitop3:0xde
    v_bitop3_b32 v25, v127, v25, s4 bitop3:0xde
    v_and_b32 v25, v6, v25
    v_cmp_ne_u32 vcc, 0, v25
    s_cbranch_vccz L_modok_79
    s_mov_b32 s80, 20007
L_poll_80:
    s_mov_b64 exec, s[30:31]
    s_cbranch_execz L_mq_74
    buffer_load_dwordx4 v[116:119], v113, s[52:55], s94 offen sc1
L_mq_74:
    s_mov_b64 exec, s[32:33]
    s_cbranch_execz L_mq_75
    buffer_load_dwordx4 v[120:123], v113, s[52:55], s95 offen sc1
L_mq_75:
    s_mov_b64 exec, s[34:35]
    s_cbranch_execz L_mq_76
    buffer_load_dwordx4 v[124:127], v113, s[52:55], s96 offen sc1
L_mq_76:
    s_mov_b64 exec, -1
    buffer_load_dwordx4 v[96:99], v112, s[52:55], s94 offen sc1
    buffer_load_dwordx4 v[100:103], v112, s[52:55], s95 offen sc1
    buffer_load_dwordx4 v[104:107], v112, s[52:55], s96 offen sc1
    s_waitcnt vmcnt(5)
    v_xor_b32 v25, s4, v116
    v_bitop3_b32 v25, v117, v25, s4 bitop3:0xde
    v_bitop3_b32 v25, v118, v25, s4 bitop3:0xde
    v_bitop3_b32 v25, v119, v25, s4 bitop3:0xde
    s_waitcnt vmcnt(4)
    v_bitop3_b32 v25, v120, v25, s4 bitop3:0xde
    v_bitop3_b32 v25, v121, v25, s4 bitop3:0xde
    v_bitop3_b32 v25, v122, v25, s4 bitop3:0xde
    v_bitop3_b32 v25, v123, v25, s4 bitop3:0xde
    s_waitcnt vmcnt(3)
    v_bitop3_b32 v25, v124, v25, s4 bitop3:0xde
    v_bitop3_b32 v25, v125, v25, s4 bitop3:0xde
    v_bitop3_b32 v25, v126, v25, s4 bitop3:0xde
    v_bitop3_b32 v25, v127, v25, s4 bitop3:0xde
    s_waitcnt vmcnt(2)
    v_bitop3_b32 v25, v96, v25, s4 bitop3:0xde
    v_bitop3_b32 v25, v97, v25, s4 bitop3:0xde
    v_bitop3_b32 v25, v98, v25, s4 bitop3:0xde
    v_bitop3_b32 v25, v99, v25, s4 bitop3:0xde
    s_waitcnt vmcnt(1)
    v_bitop3_b32 v25, v100, v25, s4 bitop3:0xde
    v_bitop3_b32 v25, v101, v25, s4 bitop3:0xde
    v_bitop3_b32 v25, v102, v25, s4 bitop3:0xde
    v_bitop3_b32 v25, v103, v25, s4 bitop3:0xde
    s_waitcnt vmcnt(0)
    v_bitop3_b32 v25, v104, v25, s4 bitop3:0xde
    v_bitop3_b32 v25, v105, v25, s4 bitop3:0xde
    v_bitop3_b32 v25, v106, v25, s4 bitop3:0xde
    v_bitop3_b32 v25, v107, v25, s4 bitop3:0xde
    v_and_b32 v25, v6, v25
    v_cmp_ne_u32 vcc, 0, v25
    s_sub_u32 s80, s80, 1
    s_cbranch_vccz L_pdone_81
    s_cmp_lg_u32 s80, 0
    s_cbranch_scc1 L_poll_80
L_pdone_81:
L_modok_79:
    v_add_f32 v96, v96, v116
    v_add_f32 v97, v97, v117
    v_add_f32 v98, v98, v118
    v_add_f32 v99, v99, v119
    v_add_f32 v100, v100, v120
    v_add_f32 v101, v101, v121
    v_add_f32 v102, v102, v122
    v_add_f32 v103, v103, v123
    v_add_f32 v104, v104, v124
    v_add_f32 v105, v105, v125
    v_add_f32 v106, v106, v126
    v_add_f32 v107, v107, v127
    v_mov_b32 v116, v96
    v_mov_b32 v117, v97
    v_mov_b32 v118, v98
    v_mov_b32 v119, v99
    v_mov_b32 v120, v100
    v_mov_b32 v121, v101
    v_mov_b32 v122, v102
    v_mov_b32 v123, v103
    v_mov_b32 v124, v104
    v_mov_b32 v125, v105
    v_mov_b32 v126, v106
    v_mov_b32 v127, v107
    v_permlane32_swap_b32 v96, v116
    v_permlane32_swap_b32 v97, v117
    v_permlane32_swap_b32 v98, v118
    v_permlane32_swap_b32 v99, v119
    v_permlane32_swap_b32 v100, v120
    v_permlane32_swap_b32 v101, v121
    v_permlane32_swap_b32 v102, v122
    v_permlane32_swap_b32 v103, v123
    v_permlane32_swap_b32 v104, v124
    v_permlane32_swap_b32 v105, v125
    v_permlane32_swap_b32 v106, v126
    v_permlane32_swap_b32 v107, v127
    v_add_f32 v96, v96, v116
    v_add_f32 v97, v97, v117
    v_add_f32 v98, v98, v118
    v_add_f32 v99, v99, v119
    v_add_f32 v100, v100, v120
    v_add_f32 v101, v101, v121
    v_add_f32 v102, v102, v122
    v_add_f32 v103, v103, v123
    v_add_f32 v104, v104, v124
    v_add_f32 v105, v105, v125
    v_add_f32 v106, v106, v126
    v_add_f32 v107, v107, v127
    v_cvt_pk_bf16_f32 v25, v96, v97
    v_lshlrev_b32 v96, 16, v25
    v_and_b32 v97, 0xffff0000, v25
    v_cvt_pk_bf16_f32 v25, v98, v99
    v_lshlrev_b32 v98, 16, v25
    v_and_b32 v99, 0xffff0000, v25
    v_cvt_pk_bf16_f32 v25, v100, v101
    v_lshlrev_b32 v100, 16, v25
    v_and_b32 v101, 0xffff0000, v25
    v_cvt_pk_bf16_f32 v25, v102, v103
    v_lshlrev_b32 v102, 16, v25
    v_and_b32 v103, 0xffff0000, v25
    v_cvt_pk_bf16_f32 v25, v104, v105
    v_lshlrev_b32 v104, 16, v25
    v_and_b32 v105, 0xffff0000, v25
    v_cvt_pk_bf16_f32 v25, v106, v107
    v_lshlrev_b32 v106, 16, v25
    v_and_b32 v107, 0xffff0000, v25
    v_add_f32 v104, 1.0, v104
    v_add_f32 v105, 1.0, v105
    v_add_f32 v106, 1.0, v106
    v_add_f32 v107, 1.0, v107
    v_cvt_pk_bf16_f32 v25, v104, v105
    v_lshlrev_b32 v104, 16, v25
    v_and_b32 v105, 0xffff0000, v25
    v_cvt_pk_bf16_f32 v25, v106, v107
    v_lshlrev_b32 v106, 16, v25
    v_and_b32 v107, 0xffff0000, v25
    s_waitcnt vmcnt(4)
    v_lshlrev_b32 v108, 16, v28
    v_and_b32 v109, 0xffff0000, v28
    v_lshlrev_b32 v110, 16, v29
    v_and_b32 v111, 0xffff0000, v29
    s_waitcnt vmcnt(3)
    v_xor_b32 v24, s4, v32
    v_bitop3_b32 v24, v33, v24, s4 bitop3:0xde
    v_bitop3_b32 v24, v34, v24, s4 bitop3:0xde
    v_bitop3_b32 v24, v35, v24, s4 bitop3:0xde
    s_waitcnt vmcnt(2)
    v_bitop3_b32 v24, v36, v24, s4 bitop3:0xde
    v_bitop3_b32 v24, v37, v24, s4 bitop3:0xde
    v_bitop3_b32 v24, v38, v24, s4 bitop3:0xde
    v_bitop3_b32 v24, v39, v24, s4 bitop3:0xde
    s_waitcnt vmcnt(1)
    v_bitop3_b32 v24, v40, v24, s4 bitop3:0xde
    v_bitop3_b32 v24, v41, v24, s4 bitop3:0xde
    v_bitop3_b32 v24, v42, v24, s4 bitop3:0xde
    v_bitop3_b32 v24, v43, v24, s4 bitop3:0xde
    s_waitcnt vmcnt(0)
    v_bitop3_b32 v24, v44, v24, s4 bitop3:0xde
    v_bitop3_b32 v24, v45, v24, s4 bitop3:0xde
    v_bitop3_b32 v24, v46, v24, s4 bitop3:0xde
    v_bitop3_b32 v24, v47, v24, s4 bitop3:0xde
    v_and_b32 v24, v6, v24
    v_cmp_ne_u32 vcc, 0, v24
    s_mov_b32 s80, 20007
    s_cbranch_vccz L_pdone_78
L_poll_77:
    buffer_load_dwordx4 v[32:35], v64, s[52:55], s77 offen sc1
    buffer_load_dwordx4 v[36:39], v65, s[52:55], s77 offen sc1
    buffer_load_dwordx4 v[40:43], v66, s[52:55], s77 offen sc1
    buffer_load_dwordx4 v[44:47], v67, s[52:55], s77 offen sc1
    s_waitcnt vmcnt(3)
    v_xor_b32 v24, s4, v32
    v_bitop3_b32 v24, v33, v24, s4 bitop3:0xde
    v_bitop3_b32 v24, v34, v24, s4 bitop3:0xde
    v_bitop3_b32 v24, v35, v24, s4 bitop3:0xde
    s_waitcnt vmcnt(2)
    v_bitop3_b32 v24, v36, v24, s4 bitop3:0xde
    v_bitop3_b32 v24, v37, v24, s4 bitop3:0xde
    v_bitop3_b32 v24, v38, v24, s4 bitop3:0xde
    v_bitop3_b32 v24, v39, v24, s4 bitop3:0xde
    s_waitcnt vmcnt(1)
    v_bitop3_b32 v24, v40, v24, s4 bitop3:0xde
    v_bitop3_b32 v24, v41, v24, s4 bitop3:0xde
    v_bitop3_b32 v24, v42, v24, s4 bitop3:0xde
    v_bitop3_b32 v24, v43, v24, s4 bitop3:0xde
    s_waitcnt vmcnt(0)
    v_bitop3_b32 v24, v44, v24, s4 bitop3:0xde
    v_bitop3_b32 v24, v45, v24, s4 bitop3:0xde
    v_bitop3_b32 v24, v46, v24, s4 bitop3:0xde
    v_bitop3_b32 v24, v47, v24, s4 bitop3:0xde
    v_and_b32 v24, v6, v24
    v_cmp_ne_u32 vcc, 0, v24
    s_sub_u32 s80, s80, 1
    s_cbranch_vccz L_pdone_78
    s_and_b32 s81, s80, 7
    s_cselect_b32 s81, 4194304, 0
    v_mad_u32_u24 v64, v69, s81, v68
    s_cmp_lg_u32 s80, 0
    s_cbranch_scc1 L_poll_77
L_pdone_78:
    v_add_f32 v32, v32, v36
    v_add_f32 v40, v40, v44
    v_add_f32 v33, v33, v37
    v_add_f32 v41, v41, v45
    v_add_f32 v34, v34, v38
    v_add_f32 v42, v42, v46
    v_add_f32 v35, v35, v39
    v_add_f32 v43, v43, v47
    v_add_f32 v32, v32, v40
    v_add_f32 v33, v33, v41
    v_add_f32 v34, v34, v42
    v_add_f32 v35, v35, v43
    v_mov_b32 v36, v32
    v_mov_b32 v37, v33
    v_mov_b32 v38, v34
    v_mov_b32 v39, v35
    v_permlane32_swap_b32 v32, v36
    v_permlane32_swap_b32 v33, v37
    v_permlane32_swap_b32 v34, v38
    v_permlane32_swap_b32 v35, v39
    v_add_f32 v32, v32, v36
    v_add_f32 v33, v33, v37
    v_add_f32 v34, v34, v38
    v_add_f32 v35, v35, v39
    v_cvt_pk_bf16_f32 v24, v32, v33
    v_lshlrev_b32 v32, 16, v24
    v_and_b32 v33, 0xffff0000, v24
    v_cvt_pk_bf16_f32 v24, v34, v35
    v_lshlrev_b32 v34, 16, v24
    v_and_b32 v35, 0xffff0000, v24
    v_mul_f32 v32, v32, v96
    v_mul_f32 v33, v33, v97
    v_mul_f32 v34, v34, v98
    v_mul_f32 v35, v35, v99
    v_cvt_pk_bf16_f32 v24, v32, v33
    v_lshlrev_b32 v32, 16, v24
    v_and_b32 v33, 0xffff0000, v24
    v_cvt_pk_bf16_f32 v24, v34, v35
    v_lshlrev_b32 v34, 16, v24
    v_and_b32 v35, 0xffff0000, v24
    v_add_f32 v32, v32, v108
    v_add_f32 v33, v33, v109
    v_add_f32 v34, v34, v110
    v_add_f32 v35, v35, v111
    v_cvt_pk_bf16_f32 v24, v32, v33
    v_lshlrev_b32 v32, 16, v24
    v_and_b32 v33, 0xffff0000, v24
    v_cvt_pk_bf16_f32 v24, v34, v35
    v_lshlrev_b32 v34, 16, v24
    v_and_b32 v35, 0xffff0000, v24
    v_add_f32 v16, v32, v33
    v_mul_f32 v17, v32, v32
    v_add_f32 v18, v34, v35
    v_fmac_f32 v17, v33, v33
    v_add_f32 v16, v16, v18
    v_fmac_f32 v17, v34, v34
    v_fmac_f32 v17, v35, v35
    v_add_f32_dpp v18, v16, v16 quad_perm:[1,0,3,2] row_mask:0xf bank_mask:0xf
    s_nop 0
    v_add_f32_dpp v19, v17, v17 quad_perm:[1,0,3,2] row_mask:0xf bank_mask:0xf
    v_add_f32_dpp v16, v18, v18 quad_perm:[2,3,0,1] row_mask:0xf bank_mask:0xf
    s_nop 0
    v_add_f32_dpp v17, v19, v19 quad_perm:[2,3,0,1] row_mask:0xf bank_mask:0xf
    v_add_f32_dpp v18, v16, v16 row_half_mirror row_mask:0xf bank_mask:0xf
    s_nop 0
    v_add_f32_dpp v19, v17, v17 row_half_mirror row_mask:0xf bank_mask:0xf
    v_add_f32_dpp v16, v18, v18 row_ror:8 row_mask:0xf bank_mask:0xf
    s_nop 0
    v_add_f32_dpp v17, v19, v19 row_ror:8 row_mask:0xf bank_mask:0xf
    v_mov_b32 v18, v16
    v_mov_b32 v19, v17
    s_nop 0
    v_permlane16_swap_b32 v16, v18
    v_permlane16_swap_b32 v17, v19
    v_add_f32 v16, v16, v18
    v_add_f32 v17, v17, v19
    ds_write_b64 v10, v[16:17] offset:320
    s_mov_b64 exec, 1
    ds_add_u32 v14, v15 offset:116
    s_mov_b64 exec, -1
    v_bfi_b32 v36, v6, s4, v32
    v_bfi_b32 v37, v6, s4, v33
    v_bfi_b32 v38, v6, s4, v34
    v_bfi_b32 v39, v6, s4, v35
    s_mov_b32 exec_hi, 0
    buffer_store_dwordx4 v[36:39], v9, s[52:55], s71 offen sc1
    s_mov_b32 exec_hi, -1
    ds_read_b32 v40, v14 offset:116
    ds_read_b128 v[16:19], v14 offset:320
    ds_read_b128 v[20:23], v14 offset:336
    ds_read_b128 v[24:27], v14 offset:352
    ds_read_b128 v[28:31], v14 offset:368
    s_waitcnt lgkmcnt(4)
    v_cmp_le_i32 vcc, 8, v40
    s_cbranch_vccnz L_lwe_84
    s_mov_b32 s80, 160000
L_lw_82:
    ds_read_b32 v40, v14 offset:116
    s_waitcnt lgkmcnt(0)
    v_cmp_le_i32 vcc, 8, v40
    s_sub_u32 s80, s80, 1
    s_cbranch_vccnz L_lwd_83
    s_cmp_lg_u32 s80, 0
    s_cbranch_scc1 L_lw_82
L_lwd_83:
    ds_read_b128 v[16:19], v14 offset:320
    ds_read_b128 v[20:23], v14 offset:336
    ds_read_b128 v[24:27], v14 offset:352
    ds_read_b128 v[28:31], v14 offset:368
L_lwe_84:
    s_waitcnt lgkmcnt(2)
    v_add_f32 v16, v16, v18
    v_add_f32 v17, v17, v19
    v_add_f32 v20, v20, v22
    v_add_f32 v21, v21, v23
    s_waitcnt lgkmcnt(0)
    v_add_f32 v24, v24, v26
    v_add_f32 v25, v25, v27
    v_add_f32 v28, v28, v30
    v_add_f32 v29, v29, v31
    v_add_f32 v16, v16, v20
    v_add_f32 v17, v17, v21
    v_add_f32 v24, v24, v28
    v_add_f32 v25, v25, v29
    v_add_f32 v16, v16, v24
    v_add_f32 v17, v17, v25
    v_mul_f32 v16, 0x3a800000, v16
    v_mul_f32 v17, 0x3a800000, v17
    v_fma_f32 v17, -v16, v16, v17
    v_max_f32 v17, 0, v17
    v_cvt_pk_bf16_f32 v18, v16, v17
    v_lshlrev_b32 v16, 16, v18
    v_and_b32 v17, 0xffff0000, v18
    v_add_f32 v17, 0x3727c5ac, v17
    v_cvt_pk_bf16_f32 v17, v17, v17
    v_lshlrev_b32 v17, 16, v17
    v_sqrt_f32 v17, v17
    s_nop 0
    v_cvt_pk_bf16_f32 v17, v17, v17
    v_lshlrev_b32 v17, 16, v17
    v_rcp_f32 v17, v17
    v_sub_f32 v32, v32, v16
    v_sub_f32 v33, v33, v16
    v_sub_f32 v34, v34, v16
    v_sub_f32 v35, v35, v16
    v_cvt_pk_bf16_f32 v24, v32, v33
    v_lshlrev_b32 v32, 16, v24
    v_and_b32 v33, 0xffff0000, v24
    v_cvt_pk_bf16_f32 v24, v34, v35
    v_lshlrev_b32 v34, 16, v24
    v_and_b32 v35, 0xffff0000, v24
    v_mul_f32 v32, v32, v17
    v_mul_f32 v33, v33, v17
    v_mul_f32 v34, v34, v17
    v_mul_f32 v35, v35, v17
    v_cvt_pk_bf16_f32 v24, v32, v33
    v_lshlrev_b32 v32, 16, v24
    v_and_b32 v33, 0xffff0000, v24
    v_cvt_pk_bf16_f32 v24, v34, v35
    v_lshlrev_b32 v34, 16, v24
    v_and_b32 v35, 0xffff0000, v24
    v_mul_f32 v32, v32, v104
    v_mul_f32 v33, v33, v105
    v_mul_f32 v34, v34, v106
    v_mul_f32 v35, v35, v107
    v_cvt_pk_bf16_f32 v24, v32, v33
    v_lshlrev_b32 v32, 16, v24
    v_and_b32 v33, 0xffff0000, v24
    v_cvt_pk_bf16_f32 v24, v34, v35
    v_lshlrev_b32 v34, 16, v24
    v_and_b32 v35, 0xffff0000, v24
    v_add_f32 v32, v32, v100
    v_add_f32 v33, v33, v101
    v_add_f32 v34, v34, v102
    v_add_f32 v35, v35, v103
    v_cvt_pk_bf16_f32 v24, v32, v33
    v_lshlrev_b32 v32, 16, v24
    v_and_b32 v33, 0xffff0000, v24
    v_cvt_pk_bf16_f32 v24, v34, v35
    v_lshlrev_b32 v34, 16, v24
    v_and_b32 v35, 0xffff0000, v24
    v_bfi_b32 v32, v6, s4, v32
    v_bfi_b32 v33, v6, s4, v33
    v_bfi_b32 v34, v6, s4, v34
    v_bfi_b32 v35, v6, s4, v35
    s_mov_b32 exec_hi, 0
    buffer_store_dwordx4 v[32:35], v9, s[52:55], s76 offen
    buffer_store_dwordx4 v[32:35], v9, s[52:55], s70 offen sc1
    s_mov_b64 exec, 1
    ds_add_u32 v14, v15 offset:120
    s_mov_b64 exec, -1
L_nor3:
    s_sub_u32 s68, s6, 16
    s_cmp_eq_u32 s6, 21
    s_cselect_b32 s68, 11, s68
    s_cmp_eq_u32 s6, 27
    s_cselect_b32 s68, 5, s68
    s_lshl_b32 s70, s5, 15
    s_lshl_b32 s67, s68, 8
    s_add_u32 s70, s70, s67
    s_lshl_b32 s67, s3, 12
    s_add_u32 s70, s70, s67
    s_add_u32 s70, s70, 2760704
    s_add_u32 s69, s70, 4194304
    v_lshlrev_b32 v8, 4, v1
    s_mul_i32 s73, s5, 14336
    s_lshl_b32 s67, s3, 11
    s_add_u32 s73, s73, s67
    s_add_u32 s73, s73, 3301376
    s_add_u32 s74, s73, 114688
    v_mul_u32_u24 v26, 114688, v1
    s_lshl_b32 s67, s68, 7
    v_add_u32 v26, s67, v26
    s_add_u32 s78, s3, 24
    s_add_u32 s79, s78, 1
    s_and_b32 s78, s78, 15
    s_lshl_b32 s78, s78, 13
    v_mul_u32_u24 v16, 272, v4
    v_lshl_add_u32 v16, v2, 4, v16
    v_add_u32 v11, s78, v16
    s_mov_b32 s67, 65536
    s_mul_i32 s77, s3, 272
    s_add_u32 s67, s67, s77
    v_add_u32 v12, s67, v13
    s_cmp_ge_u32 s3, 7
    s_cbranch_scc1 L_p5skip_85
    s_add_u32 s78, s3, 24
    s_add_u32 s79, s78, 1
    s_and_b32 s78, s78, 15
    s_lshl_b32 s78, s78, 13
    v_add_u32 v164, s78, v160
    v_add_u32 v165, s78, v161
    v_add_u32 v166, s78, v162
    v_add_u32 v167, s78, v163
    s_mov_b32 s80, 160000
L_lw_86:
    ds_read_b32 v16, v14 offset:0
    s_waitcnt lgkmcnt(0)
    v_cmp_le_i32 vcc, s79, v16
    s_sub_u32 s80, s80, 1
    s_cbranch_vccnz L_lwd_87
    s_nop 15
    s_nop 15
    s_nop 15
    s_cmp_lg_u32 s80, 0
    s_cbranch_scc1 L_lw_86
L_lwd_87:
L_lwe_88:
    ds_read_b64_tr_b16 v[64:65], v164 offset:0
    ds_read_b64_tr_b16 v[66:67], v164 offset:2048
    ds_read_b64_tr_b16 v[68:69], v164 offset:4096
    ds_read_b64_tr_b16 v[70:71], v164 offset:6144
    ds_read_b64_tr_b16 v[72:73], v165 offset:0
    ds_read_b64_tr_b16 v[74:75], v165 offset:2048
    ds_read_b64_tr_b16 v[76:77], v165 offset:4096
    ds_read_b64_tr_b16 v[78:79], v165 offset:6144
    ds_read_b64_tr_b16 v[80:81], v166 offset:0
    ds_read_b64_tr_b16 v[82:83], v166 offset:2048
    ds_read_b64_tr_b16 v[84:85], v166 offset:4096
    ds_read_b64_tr_b16 v[86:87], v166 offset:6144
    ds_read_b64_tr_b16 v[88:89], v167 offset:0
    ds_read_b64_tr_b16 v[90:91], v167 offset:2048
    ds_read_b64_tr_b16 v[92:93], v167 offset:4096
    ds_read_b64_tr_b16 v[94:95], v167 offset:6144
    s_waitcnt lgkmcnt(0)
    s_mov_b32 exec_lo, 0x3
    s_mov_b32 exec_hi, 0x0
    s_add_u32 s75, s73, 4194304
    s_add_u32 s76, s74, 4194304
    s_mov_b32 s80, 20007
L_poll_89:
    buffer_load_dword v25, v26, s[52:55], s75 offen sc1
    s_waitcnt vmcnt(0)
    v_xor_b32 v24, s4, v25
    v_and_b32 v24, v6, v24
    v_cmp_ne_u32 vcc, 0, v24
    s_sub_u32 s80, s80, 1
    s_cbranch_vccz L_pdone_90
    s_and_b32 s81, s80, 7
    s_cselect_b32 s81, 4194304, 0
    s_add_u32 s75, s73, s81
    s_add_u32 s76, s74, s81
    s_cmp_lg_u32 s80, 0
    s_cbranch_scc1 L_poll_89
L_pdone_90:
    s_mov_b64 exec, -1
    s_mov_b32 s80, 20007
L_poll_91:
    buffer_load_dwordx4 v[32:35], v8, s[52:55], s75 offen offset:0 sc1
    buffer_load_dwordx4 v[36:39], v8, s[52:55], s75 offen offset:1024 sc1
    buffer_load_dwordx4 v[40:43], v8, s[52:55], s76 offen offset:0 sc1
    buffer_load_dwordx4 v[44:47], v8, s[52:55], s76 offen offset:1024 sc1
    s_waitcnt vmcnt(3)
    v_xor_b32 v24, s4, v32
    v_bitop3_b32 v24, v33, v24, s4 bitop3:0xde
    v_bitop3_b32 v24, v34, v24, s4 bitop3:0xde
    v_bitop3_b32 v24, v35, v24, s4 bitop3:0xde
    s_waitcnt vmcnt(2)
    v_bitop3_b32 v24, v36, v24, s4 bitop3:0xde
    v_bitop3_b32 v24, v37, v24, s4 bitop3:0xde
    v_bitop3_b32 v24, v38, v24, s4 bitop3:0xde
    v_bitop3_b32 v24, v39, v24, s4 bitop3:0xde
    s_waitcnt vmcnt(1)
    v_bitop3_b32 v24, v40, v24, s4 bitop3:0xde
    v_bitop3_b32 v24, v41, v24, s4 bitop3:0xde
    v_bitop3_b32 v24, v42, v24, s4 bitop3:0xde
    v_bitop3_b32 v24, v43, v24, s4 bitop3:0xde
    s_waitcnt vmcnt(0)
    v_bitop3_b32 v24, v44, v24, s4 bitop3:0xde
    v_bitop3_b32 v24, v45, v24, s4 bitop3:0xde
    v_bitop3_b32 v24, v46, v24, s4 bitop3:0xde
    v_bitop3_b32 v24, v47, v24, s4 bitop3:0xde
    v_and_b32 v24, v6, v24
    v_cmp_ne_u32 vcc, 0, v24
    s_sub_u32 s80, s80, 1
    s_cbranch_vccz L_pdone_92
    s_and_b32 s81, s80, 7
    s_cselect_b32 s81, 4194304, 0
    s_add_u32 s75, s73, s81
    s_add_u32 s76, s74, s81
    s_cmp_lg_u32 s80, 0
    s_cbranch_scc1 L_poll_91
L_pdone_92:
    v_and_b32 v32, 0xffff0000, v32
    v_and_b32 v33, 0xffff0000, v33
    v_and_b32 v34, 0xffff0000, v34
    v_and_b32 v35, 0xffff0000, v35
    v_and_b32 v36, 0xffff0000, v36
    v_and_b32 v37, 0xffff0000, v37
    v_and_b32 v38, 0xffff0000, v38
    v_and_b32 v39, 0xffff0000, v39
    v_and_b32 v40, 0xffff0000, v40
    v_and_b32 v41, 0xffff0000, v41
    v_and_b32 v42, 0xffff0000, v42
    v_and_b32 v43, 0xffff0000, v43
    v_and_b32 v44, 0xffff0000, v44
    v_and_b32 v45, 0xffff0000, v45
    v_and_b32 v46, 0xffff0000, v46
    v_and_b32 v47, 0xffff0000, v47
    v_mul_f32 v32, v32, v40
    v_mul_f32 v33, v33, v41
    v_mul_f32 v34, v34, v42
    v_mul_f32 v35, v35, v43
    v_mul_f32 v36, v36, v44
    v_mul_f32 v37, v37, v45
    v_mul_f32 v38, v38, v46
    v_mul_f32 v39, v39, v47
    v_cvt_pk_bf16_f32 v48, v32, v33
    v_cvt_pk_bf16_f32 v49, v34, v35
    v_cvt_pk_bf16_f32 v50, v36, v37
    v_cvt_pk_bf16_f32 v51, v38, v39
L_p5skip_85:
    s_cmp_ge_u32 s3, 7
    s_cbranch_scc1 L_nomm_93
    v_mfma_f32_16x16x32_bf16 v[32:35], v[64:67], v[48:51], 0
    v_mov_b32_dpp v52, v48 row_ror:8 row_mask:0xf bank_mask:0xf
    v_mfma_f32_16x16x32_bf16 v[36:39], v[72:75], v[48:51], 0
    v_mov_b32_dpp v53, v49 row_ror:8 row_mask:0xf bank_mask:0xf
    v_mfma_f32_16x16x32_bf16 v[40:43], v[80:83], v[48:51], 0
    v_mov_b32_dpp v54, v50 row_ror:8 row_mask:0xf bank_mask:0xf
    v_mfma_f32_16x16x32_bf16 v[44:47], v[88:91], v[48:51], 0
    v_mov_b32_dpp v55, v51 row_ror:8 row_mask:0xf bank_mask:0xf
    s_nop 1
    v_mfma_f32_16x16x32_bf16 v[32:35], v[68:71], v[52:55], v[32:35]
    v_mfma_f32_16x16x32_bf16 v[36:39], v[76:79], v[52:55], v[36:39]
    v_mfma_f32_16x16x32_bf16 v[40:43], v[84:87], v[52:55], v[40:43]
    v_mfma_f32_16x16x32_bf16 v[44:47], v[92:95], v[52:55], v[44:47]
    s_mov_b64 exec, s[84:85]
    s_nop 3
    ds_write_b128 v11, v[32:35] offset:0
    ds_write_b128 v11, v[36:39] offset:64
    ds_write_b128 v11, v[40:43] offset:128
    ds_write_b128 v11, v[44:47] offset:192
    s_mov_b64 exec, 1
    ds_add_u32 v14, v15 offset:128
    s_mov_b64 exec, -1
L_nomm_93:
    s_mov_b32 s80, 160000
L_lw_94:
    ds_read_b32 v24, v14 offset:128
    ds_read2st64_b32 v[16:17], v12 offset0:0 offset1:32
    ds_read2st64_b32 v[18:19], v12 offset0:64 offset1:96
    ds_read2st64_b32 v[20:21], v12 offset0:128 offset1:160
    ds_read_b32 v22, v12 offset:49152
    s_sub_u32 s80, s80, 1
    s_cbranch_scc1 L_lwe_96
    s_waitcnt lgkmcnt(4)
    v_cmp_le_i32 vcc, 7, v24
    s_cbranch_vccz L_lw_94
L_lwe_96:
    s_waitcnt lgkmcnt(3)
    v_add_f32 v16, v16, v17
    s_waitcnt lgkmcnt(2)
    v_add_f32 v16, v16, v18
    v_add_f32 v16, v16, v19
    s_waitcnt lgkmcnt(1)
    v_add_f32 v16, v16, v20
    v_add_f32 v16, v16, v21
    s_waitcnt lgkmcnt(0)
    v_add_f32 v16, v16, v22
    v_bfi_b32 v16, v6, s4, v16
    buffer_store_dword v16, v13, s[52:55], s69 offen
    buffer_store_dword v16, v13, s[52:55], s70 offen sc1
    s_branch L_done
L_lrest:
    s_and_b32 s69, s5, 1
    s_lshl_b32 s69, s69, 2
    s_lshr_b32 s67, s6, 2
    s_add_u32 s69, s69, s67
    s_lshl_b32 s69, s69, 2
    s_add_u32 s69, s69, s65
    s_lshl_b32 s69, s69, 20
    s_and_b32 s67, s6, 1
    s_mul_i32 s67, s67, 1024
    s_add_u32 s69, s69, s67
    s_bfe_u32 s67, s6, 0x10001
    s_mul_i32 s67, s67, 2048
    s_add_u32 s69, s69, s67
    s_add_u32 s69, s69, 786432
    s_lshr_b32 s67, s6, 1
    s_add_u32 s67, s67, s5
    s_and_b32 s67, s67, 7
    s_mul_i32 s67, s67, 4096
    s_add_u32 s69, s69, s67
    s_waitcnt vmcnt(24)
    s_sub_u32 s67, s72, 3
    v_mov_b32 v20, s67
    ds_max_i32 v19, v20 offset:0
    s_waitcnt vmcnt(16)
    s_sub_u32 s67, s72, 2
    v_mov_b32 v20, s67
    ds_max_i32 v19, v20 offset:0
    s_waitcnt vmcnt(8)
    s_sub_u32 s67, s72, 1
    v_mov_b32 v20, s67
    ds_max_i32 v19, v20 offset:0
    s_waitcnt vmcnt(0)
    s_sub_u32 s67, s72, 0
    v_mov_b32 v20, s67
    ds_max_i32 v19, v20 offset:0
    s_mov_b32 s80, 160000
L_lw_97:
    ds_read_b32 v16, v14 offset:136
    s_waitcnt lgkmcnt(0)
    v_cmp_le_i32 vcc, 4, v16
    s_sub_u32 s80, s80, 1
    s_cbranch_vccnz L_lwd_98
    s_cmp_lg_u32 s80, 0
    s_cbranch_scc1 L_lw_97
L_lwd_98:
L_lwe_99:
L_lk:
    s_mov_b32 s66, s69
    v_xor_b32 v16, v3, v2
    v_lshlrev_b32 v16, 4, v16
    v_lshl_add_u32 v24, v2, 8, v16
    v_xor_b32 v25, 64, v24
    v_add_u32 v25, 31744, v25
    v_xor_b32 v26, 128, v24
    v_add_u32 v26, 63488, v26
    v_xor_b32 v27, 192, v24
    v_add_u32 v27, 95232, v27
    v_xor_b32 v28, 0, v24
    v_add_u32 v28, 131072, v28
    v_xor_b32 v29, 64, v24
    v_add_u32 v29, 162816, v29
    v_xor_b32 v30, 128, v24
    v_add_u32 v30, 194560, v30
    v_xor_b32 v31, 192, v24
    v_add_u32 v31, 226304, v31
    s_mov_b32 s75, -8
L_seg_102:
    s_mov_b32 m0, s73
    s_waitcnt vmcnt(52)
    buffer_load_dwordx4 v24, s[12:15], s66 offen offset:0 nt lds
    buffer_load_dwordx4 v25, s[12:15], s66 offen offset:1024 nt lds
    buffer_load_dwordx4 v26, s[12:15], s66 offen offset:2048 nt lds
    buffer_load_dwordx4 v27, s[12:15], s66 offen offset:3072 nt lds
    s_add_u32 m0, s73, 4096
    s_waitcnt vmcnt(52)
    s_sub_u32 s67, s72, 6
    v_mov_b32 v20, s67
    ds_max_i32 v19, v20 offset:0
    buffer_load_dwordx4 v28, s[12:15], s66 offen offset:0 nt lds
    s_add_u32 s73, s73, 8192
    buffer_load_dwordx4 v29, s[12:15], s66 offen offset:1024 nt lds
    buffer_load_dwordx4 v30, s[12:15], s66 offen offset:2048 nt lds
    s_add_u32 s72, s72, 1
    buffer_load_dwordx4 v31, s[12:15], s66 offen offset:3072 nt lds
    s_add_u32 s67, s66, 4096
    s_and_b32 s67, s67, 28672
    s_andn2_b32 s66, s66, 28672
    s_or_b32 s66, s66, s67
    s_add_u32 s75, s75, 1
    s_cbranch_scc0 L_seg_102
    s_mov_b32 s66, s69
    v_lshlrev_b32 v16, 1, v2
    v_xor_b32 v16, v3, v16
    v_lshlrev_b32 v16, 4, v16
    v_lshl_add_u32 v24, v2, 8, v16
    v_xor_b32 v25, 128, v24
    v_add_u32 v25, 31744, v25
    v_xor_b32 v26, 0, v24
    v_add_u32 v26, 63488, v26
    v_xor_b32 v27, 128, v24
    v_add_u32 v27, 95232, v27
    v_xor_b32 v28, 0, v24
    v_add_u32 v28, 131072, v28
    v_xor_b32 v29, 128, v24
    v_add_u32 v29, 162816, v29
    v_xor_b32 v30, 0, v24
    v_add_u32 v30, 194560, v30
    v_xor_b32 v31, 128, v24
    v_add_u32 v31, 226304, v31
    s_mov_b32 s75, -8
    s_lshr_b32 s67, s73, 11
    v_add_u32 v22, s67, v14
    ds_read_b32 v21, v22 offset:4
L_seg_105:
    s_waitcnt lgkmcnt(0)
    v_cmp_le_i32 vcc, s74, v21
    s_cbranch_vccnz L_cok_106
    ds_read_b32 v21, v22 offset:4
    s_waitcnt lgkmcnt(0)
    v_cmp_le_i32 vcc, s74, v21
    s_cbranch_vccnz L_cok_106
    s_waitcnt vmcnt(0)
    s_sub_u32 s67, s72, 0
    v_mov_b32 v20, s67
    ds_max_i32 v19, v20 offset:0
    s_mov_b32 s80, 160000
L_csp_107:
    ds_read_b32 v21, v22 offset:4
    s_waitcnt lgkmcnt(0)
    v_cmp_le_i32 vcc, s74, v21
    s_sub_u32 s80, s80, 1
    s_cbranch_vccnz L_cok_106
    s_cmp_lg_u32 s80, 0
    s_cbranch_scc1 L_csp_107
L_cok_106:
    s_mov_b32 m0, s73
    s_waitcnt vmcnt(52)
    buffer_load_dwordx4 v24, s[16:19], s66 offen offset:0 nt lds
    buffer_load_dwordx4 v25, s[16:19], s66 offen offset:1024 nt lds
    buffer_load_dwordx4 v26, s[16:19], s66 offen offset:2048 nt lds
    buffer_load_dwordx4 v27, s[16:19], s66 offen offset:3072 nt lds
    s_add_u32 m0, s73, 4096
    s_waitcnt vmcnt(52)
    s_sub_u32 s67, s72, 6
    v_mov_b32 v20, s67
    ds_max_i32 v19, v20 offset:0
    buffer_load_dwordx4 v28, s[16:19], s66 offen offset:0 nt lds
    s_add_u32 s73, s73, 8192
    s_cmp_ge_u32 s73, 131072
    s_cselect_b32 s73, 0, s73
    s_cselect_b32 s67, 8, 0
    s_add_u32 s74, s74, s67
    buffer_load_dwordx4 v29, s[16:19], s66 offen offset:1024 nt lds
    s_lshr_b32 s67, s73, 11
    v_add_u32 v22, s67, v14
    ds_read_b32 v21, v22 offset:4
    buffer_load_dwordx4 v30, s[16:19], s66 offen offset:2048 nt lds
    s_add_u32 s72, s72, 1
    buffer_load_dwordx4 v31, s[16:19], s66 offen offset:3072 nt lds
    s_add_u32 s67, s66, 4096
    s_and_b32 s67, s67, 28672
    s_andn2_b32 s66, s66, 28672
    s_or_b32 s66, s66, s67
    s_add_u32 s75, s75, 1
    s_cbranch_scc0 L_seg_105
    s_waitcnt vmcnt(48)
    s_sub_u32 s67, s72, 6
    v_mov_b32 v20, s67
    ds_max_i32 v19, v20 offset:0
    s_waitcnt vmcnt(40)
    s_sub_u32 s67, s72, 5
    v_mov_b32 v20, s67
    ds_max_i32 v19, v20 offset:0
    s_waitcnt vmcnt(32)
    s_sub_u32 s67, s72, 4
    v_mov_b32 v20, s67
    ds_max_i32 v19, v20 offset:0
    s_waitcnt vmcnt(24)
    s_sub_u32 s67, s72, 3
    v_mov_b32 v20, s67
    ds_max_i32 v19, v20 offset:0
    s_waitcnt vmcnt(16)
    s_sub_u32 s67, s72, 2
    v_mov_b32 v20, s67
    ds_max_i32 v19, v20 offset:0
    s_waitcnt vmcnt(8)
    s_sub_u32 s67, s72, 1
    v_mov_b32 v20, s67
    ds_max_i32 v19, v20 offset:0
    s_waitcnt vmcnt(0)
    s_sub_u32 s67, s72, 0
    v_mov_b32 v20, s67
    ds_max_i32 v19, v20 offset:0
    s_cmp_lt_u32 s6, 12
    s_cbranch_scc1 L_lw4
    s_cmp_lt_u32 s6, 14
    s_cbranch_scc1 L_lw3
    s_and_b32 s67, s2, 0x7b
    s_cmp_lg_u32 s67, 121
    s_cbranch_scc1 L_lw4
L_lw3:
    s_mov_b32 s80, 160000
L_lw_108:
    ds_read_b32 v16, v14 offset:92
    s_waitcnt lgkmcnt(0)
    v_cmp_le_i32 vcc, 8, v16
    s_sub_u32 s80, s80, 1
    s_cbranch_vccnz L_lwd_109
    s_cmp_lg_u32 s80, 0
    s_cbranch_scc1 L_lw_108
L_lwd_109:
L_lwe_110:
    s_branch L_lw5
L_lw4:
    s_mov_b32 s80, 160000
L_lw_111:
    ds_read_b32 v16, v14 offset:100
    s_waitcnt lgkmcnt(0)
    v_cmp_le_i32 vcc, 8, v16
    s_sub_u32 s80, s80, 1
    s_cbranch_vccnz L_lwd_112
    s_cmp_lg_u32 s80, 0
    s_cbranch_scc1 L_lw_111
L_lwd_112:
L_lwe_113:
L_lw5:
    s_cmp_ge_u32 s6, 14
    s_cbranch_scc1 L_lgb
    s_add_u32 s66, s5, 3
    s_and_b32 s66, s66, 7
    s_lshr_b32 s67, s6, 1
    s_add_u32 s66, s66, s67
    s_add_u32 s66, s66, 1
    s_cmp_ge_u32 s66, 7
    s_cselect_b32 s67, 7, 0
    s_sub_u32 s66, s66, s67
    s_cmp_ge_u32 s66, 7
    s_cselect_b32 s67, 7, 0
    s_sub_u32 s66, s66, s67
    s_mul_i32 s67, s5, 7
    s_add_u32 s66, s66, s67
    s_lshl_b32 s66, s66, 7
    s_and_b32 s67, s6, 1
    s_cselect_b32 s60, s32, s28
    s_cselect_b32 s61, s33, s29
    s_mov_b32 s62, 7340032
    s_mov_b32 s63, 0x20000
    v_mul_u32_u24 v24, 7168, v8
    v_add_u32 v24, v24, v9
    v_add_u32 v25, 56320, v24
    v_add_u32 v26, 112640, v24
    v_add_u32 v27, 168960, v24
    v_add_u32 v28, 229376, v24
    v_add_u32 v29, 285696, v24
    v_add_u32 v30, 342016, v24
    v_add_u32 v31, 398336, v24
    s_mov_b32 s75, -3
    s_lshr_b32 s67, s73, 11
    v_add_u32 v22, s67, v14
    ds_read_b32 v21, v22 offset:4
L_seg_116:
    s_waitcnt lgkmcnt(0)
    v_cmp_le_i32 vcc, s74, v21
    s_cbranch_vccnz L_cok_117
    ds_read_b32 v21, v22 offset:4
    s_waitcnt lgkmcnt(0)
    v_cmp_le_i32 vcc, s74, v21
    s_cbranch_vccnz L_cok_117
    s_waitcnt vmcnt(0)
    s_sub_u32 s67, s72, 0
    v_mov_b32 v20, s67
    ds_max_i32 v19, v20 offset:0
    s_mov_b32 s80, 160000
L_csp_118:
    ds_read_b32 v21, v22 offset:4
    s_waitcnt lgkmcnt(0)
    v_cmp_le_i32 vcc, s74, v21
    s_sub_u32 s80, s80, 1
    s_cbranch_vccnz L_cok_117
    s_cmp_lg_u32 s80, 0
    s_cbranch_scc1 L_csp_118
L_cok_117:
    s_mov_b32 m0, s73
    s_waitcnt vmcnt(20)
    buffer_load_dwordx4 v24, s[60:63], s66 offen offset:0 nt lds
    buffer_load_dwordx4 v25, s[60:63], s66 offen offset:1024 nt lds
    buffer_load_dwordx4 v26, s[60:63], s66 offen offset:2048 nt lds
    buffer_load_dwordx4 v27, s[60:63], s66 offen offset:3072 nt lds
    s_add_u32 m0, s73, 4096
    s_waitcnt vmcnt(20)
    s_sub_u32 s67, s72, 2
    v_mov_b32 v20, s67
    ds_max_i32 v19, v20 offset:0
    buffer_load_dwordx4 v28, s[60:63], s66 offen offset:0 nt lds
    s_add_u32 s73, s73, 8192
    s_cmp_ge_u32 s73, 131072
    s_cselect_b32 s73, 0, s73
    s_cselect_b32 s67, 8, 0
    s_add_u32 s74, s74, s67
    buffer_load_dwordx4 v29, s[60:63], s66 offen offset:1024 nt lds
    s_lshr_b32 s67, s73, 11
    v_add_u32 v22, s67, v14
    ds_read_b32 v21, v22 offset:4
    buffer_load_dwordx4 v30, s[60:63], s66 offen offset:2048 nt lds
    s_add_u32 s72, s72, 1
    buffer_load_dwordx4 v31, s[60:63], s66 offen offset:3072 nt lds
    s_add_u32 s66, s66, 458752
    s_add_u32 s75, s75, 1
    s_cbranch_scc0 L_seg_116
    s_mov_b32 s80, 160000
L_lw_119:
    ds_read_b32 v16, v14 offset:100
    s_waitcnt lgkmcnt(0)
    v_cmp_le_i32 vcc, 8, v16
    s_sub_u32 s80, s80, 1
    s_cbranch_vccnz L_lwd_120
    s_cmp_lg_u32 s80, 0
    s_cbranch_scc1 L_lw_119
L_lwd_120:
L_lwe_121:
    s_mov_b32 s75, -13
    s_lshr_b32 s67, s73, 11
    v_add_u32 v22, s67, v14
    ds_read_b32 v21, v22 offset:4
L_seg_124:
    s_waitcnt lgkmcnt(0)
    v_cmp_le_i32 vcc, s74, v21
    s_cbranch_vccnz L_cok_125
    ds_read_b32 v21, v22 offset:4
    s_waitcnt lgkmcnt(0)
    v_cmp_le_i32 vcc, s74, v21
    s_cbranch_vccnz L_cok_125
    s_waitcnt vmcnt(0)
    s_sub_u32 s67, s72, 0
    v_mov_b32 v20, s67
    ds_max_i32 v19, v20 offset:0
    s_mov_b32 s80, 160000
L_csp_126:
    ds_read_b32 v21, v22 offset:4
    s_waitcnt lgkmcnt(0)
    v_cmp_le_i32 vcc, s74, v21
    s_sub_u32 s80, s80, 1
    s_cbranch_vccnz L_cok_125
    s_cmp_lg_u32 s80, 0
    s_cbranch_scc1 L_csp_126
L_cok_125:
    s_mov_b32 m0, s73
    s_waitcnt vmcnt(52)
    buffer_load_dwordx4 v24, s[60:63], s66 offen offset:0 nt lds
    buffer_load_dwordx4 v25, s[60:63], s66 offen offset:1024 nt lds
    buffer_load_dwordx4 v26, s[60:63], s66 offen offset:2048 nt lds
    buffer_load_dwordx4 v27, s[60:63], s66 offen offset:3072 nt lds
    s_add_u32 m0, s73, 4096
    s_waitcnt vmcnt(52)
    s_sub_u32 s67, s72, 6
    v_mov_b32 v20, s67
    ds_max_i32 v19, v20 offset:0
    buffer_load_dwordx4 v28, s[60:63], s66 offen offset:0 nt lds
    s_add_u32 s73, s73, 8192
    s_cmp_ge_u32 s73, 131072
    s_cselect_b32 s73, 0, s73
    s_cselect_b32 s67, 8, 0
    s_add_u32 s74, s74, s67
    buffer_load_dwordx4 v29, s[60:63], s66 offen offset:1024 nt lds
    s_lshr_b32 s67, s73, 11
    v_add_u32 v22, s67, v14
    ds_read_b32 v21, v22 offset:4
    buffer_load_dwordx4 v30, s[60:63], s66 offen offset:2048 nt lds
    s_add_u32 s72, s72, 1
    buffer_load_dwordx4 v31, s[60:63], s66 offen offset:3072 nt lds
    s_add_u32 s66, s66, 458752
    s_add_u32 s75, s75, 1
    s_cbranch_scc0 L_seg_124
    s_waitcnt vmcnt(48)
    s_sub_u32 s67, s72, 6
    v_mov_b32 v20, s67
    ds_max_i32 v19, v20 offset:0
    s_waitcnt vmcnt(40)
    s_sub_u32 s67, s72, 5
    v_mov_b32 v20, s67
    ds_max_i32 v19, v20 offset:0
    s_waitcnt vmcnt(32)
    s_sub_u32 s67, s72, 4
    v_mov_b32 v20, s67
    ds_max_i32 v19, v20 offset:0
    s_waitcnt vmcnt(24)
    s_sub_u32 s67, s72, 3
    v_mov_b32 v20, s67
    ds_max_i32 v19, v20 offset:0
    s_waitcnt vmcnt(16)
    s_sub_u32 s67, s72, 2
    v_mov_b32 v20, s67
    ds_max_i32 v19, v20 offset:0
    s_waitcnt vmcnt(8)
    s_sub_u32 s67, s72, 1
    v_mov_b32 v20, s67
    ds_max_i32 v19, v20 offset:0
    s_waitcnt vmcnt(0)
    s_sub_u32 s67, s72, 0
    v_mov_b32 v20, s67
    ds_max_i32 v19, v20 offset:0
    s_branch L_done
L_lgb:
    s_lshl_b32 s66, s5, 1
    s_add_u32 s66, s66, s6
    s_lshl_b32 s66, s66, 7
    s_add_u32 s66, s66, 8448
    v_mul_u32_u24 v24, 12288, v8
    v_add_u32 v24, v24, v9
    v_add_u32 v25, 97280, v24
    v_add_u32 v26, 194560, v24
    v_add_u32 v27, 291840, v24
    v_add_u32 v28, 393216, v24
    v_add_u32 v29, 490496, v24
    v_add_u32 v30, 587776, v24
    v_add_u32 v31, 685056, v24
    s_mov_b32 s75, -2
    s_lshr_b32 s67, s73, 11
    v_add_u32 v22, s67, v14
    ds_read_b32 v21, v22 offset:4
L_seg_129:
    s_waitcnt lgkmcnt(0)
    v_cmp_le_i32 vcc, s74, v21
    s_cbranch_vccnz L_cok_130
    ds_read_b32 v21, v22 offset:4
    s_waitcnt lgkmcnt(0)
    v_cmp_le_i32 vcc, s74, v21
    s_cbranch_vccnz L_cok_130
    s_waitcnt vmcnt(0)
    s_sub_u32 s67, s72, 0
    v_mov_b32 v20, s67
    ds_max_i32 v19, v20 offset:0
    s_mov_b32 s80, 160000
L_csp_131:
    ds_read_b32 v21, v22 offset:4
    s_waitcnt lgkmcnt(0)
    v_cmp_le_i32 vcc, s74, v21
    s_sub_u32 s80, s80, 1
    s_cbranch_vccnz L_cok_130
    s_cmp_lg_u32 s80, 0
    s_cbranch_scc1 L_csp_131
L_cok_130:
    s_mov_b32 m0, s73
    s_waitcnt vmcnt(12)
    buffer_load_dwordx4 v24, s[44:47], s66 offen offset:0 nt lds
    buffer_load_dwordx4 v25, s[44:47], s66 offen offset:1024 nt lds
    buffer_load_dwordx4 v26, s[44:47], s66 offen offset:2048 nt lds
    buffer_load_dwordx4 v27, s[44:47], s66 offen offset:3072 nt lds
    s_add_u32 m0, s73, 4096
    s_waitcnt vmcnt(12)
    s_sub_u32 s67, s72, 1
    v_mov_b32 v20, s67
    ds_max_i32 v19, v20 offset:0
    buffer_load_dwordx4 v28, s[44:47], s66 offen offset:0 nt lds
    s_add_u32 s73, s73, 8192
    s_cmp_ge_u32 s73, 131072
    s_cselect_b32 s73, 0, s73
    s_cselect_b32 s67, 8, 0
    s_add_u32 s74, s74, s67
    buffer_load_dwordx4 v29, s[44:47], s66 offen offset:1024 nt lds
    s_lshr_b32 s67, s73, 11
    v_add_u32 v22, s67, v14
    ds_read_b32 v21, v22 offset:4
    buffer_load_dwordx4 v30, s[44:47], s66 offen offset:2048 nt lds
    s_add_u32 s72, s72, 1
    buffer_load_dwordx4 v31, s[44:47], s66 offen offset:3072 nt lds
    s_add_u32 s66, s66, 786432
    s_add_u32 s75, s75, 1
    s_cbranch_scc0 L_seg_129
    s_mov_b32 s80, 160000
L_lw_132:
    ds_read_b32 v16, v14 offset:100
    s_waitcnt lgkmcnt(0)
    v_cmp_le_i32 vcc, 8, v16
    s_sub_u32 s80, s80, 1
    s_cbranch_vccnz L_lwd_133
    s_cmp_lg_u32 s80, 0
    s_cbranch_scc1 L_lw_132
L_lwd_133:
L_lwe_134:
    s_mov_b32 s75, -14
    s_lshr_b32 s67, s73, 11
    v_add_u32 v22, s67, v14
    ds_read_b32 v21, v22 offset:4
L_seg_137:
    s_waitcnt lgkmcnt(0)
    v_cmp_le_i32 vcc, s74, v21
    s_cbranch_vccnz L_cok_138
    ds_read_b32 v21, v22 offset:4
    s_waitcnt lgkmcnt(0)
    v_cmp_le_i32 vcc, s74, v21
    s_cbranch_vccnz L_cok_138
    s_waitcnt vmcnt(0)
    s_sub_u32 s67, s72, 0
    v_mov_b32 v20, s67
    ds_max_i32 v19, v20 offset:0
    s_mov_b32 s80, 160000
L_csp_139:
    ds_read_b32 v21, v22 offset:4
    s_waitcnt lgkmcnt(0)
    v_cmp_le_i32 vcc, s74, v21
    s_sub_u32 s80, s80, 1
    s_cbranch_vccnz L_cok_138
    s_cmp_lg_u32 s80, 0
    s_cbranch_scc1 L_csp_139
L_cok_138:
    s_mov_b32 m0, s73
    s_waitcnt vmcnt(28)
    buffer_load_dwordx4 v24, s[44:47], s66 offen offset:0 nt lds
    buffer_load_dwordx4 v25, s[44:47], s66 offen offset:1024 nt lds
    buffer_load_dwordx4 v26, s[44:47], s66 offen offset:2048 nt lds
    buffer_load_dwordx4 v27, s[44:47], s66 offen offset:3072 nt lds
    s_add_u32 m0, s73, 4096
    s_waitcnt vmcnt(28)
    s_sub_u32 s67, s72, 3
    v_mov_b32 v20, s67
    ds_max_i32 v19, v20 offset:0
    buffer_load_dwordx4 v28, s[44:47], s66 offen offset:0 nt lds
    s_add_u32 s73, s73, 8192
    s_cmp_ge_u32 s73, 131072
    s_cselect_b32 s73, 0, s73
    s_cselect_b32 s67, 8, 0
    s_add_u32 s74, s74, s67
    buffer_load_dwordx4 v29, s[44:47], s66 offen offset:1024 nt lds
    s_lshr_b32 s67, s73, 11
    v_add_u32 v22, s67, v14
    ds_read_b32 v21, v22 offset:4
    buffer_load_dwordx4 v30, s[44:47], s66 offen offset:2048 nt lds
    s_add_u32 s72, s72, 1
    buffer_load_dwordx4 v31, s[44:47], s66 offen offset:3072 nt lds
    s_add_u32 s66, s66, 786432
    s_add_u32 s75, s75, 1
    s_cbranch_scc0 L_seg_137
    s_waitcnt vmcnt(24)
    s_sub_u32 s67, s72, 3
    v_mov_b32 v20, s67
    ds_max_i32 v19, v20 offset:0
    s_waitcnt vmcnt(16)
    s_sub_u32 s67, s72, 2
    v_mov_b32 v20, s67
    ds_max_i32 v19, v20 offset:0
    s_waitcnt vmcnt(8)
    s_sub_u32 s67, s72, 1
    v_mov_b32 v20, s67
    ds_max_i32 v19, v20 offset:0
    s_waitcnt vmcnt(0)
    s_sub_u32 s67, s72, 0
    v_mov_b32 v20, s67
    ds_max_i32 v19, v20 offset:0
    s_branch L_done
L_LB:
    s_barrier
    s_waitcnt vmcnt(48)
    s_sub_u32 s67, s72, 6
    v_mov_b32 v20, s67
    ds_max_i32 v19, v20 offset:0
    s_waitcnt vmcnt(40)
    s_sub_u32 s67, s72, 5
    v_mov_b32 v20, s67
    ds_max_i32 v19, v20 offset:0
    s_waitcnt vmcnt(32)
    s_sub_u32 s67, s72, 4
    v_mov_b32 v20, s67
    ds_max_i32 v19, v20 offset:0
    s_waitcnt vmcnt(24)
    s_sub_u32 s67, s72, 3
    v_mov_b32 v20, s67
    ds_max_i32 v19, v20 offset:0
    s_waitcnt vmcnt(16)
    s_sub_u32 s67, s72, 2
    v_mov_b32 v20, s67
    ds_max_i32 v19, v20 offset:0
    s_waitcnt vmcnt(8)
    s_sub_u32 s67, s72, 1
    v_mov_b32 v20, s67
    ds_max_i32 v19, v20 offset:0
    s_waitcnt vmcnt(0)
    s_sub_u32 s67, s72, 0
    v_mov_b32 v20, s67
    ds_max_i32 v19, v20 offset:0
    s_and_b32 s70, s6, 1
    s_lshl_b32 s70, s70, 1
    s_and_b32 s67, s6, 3
    s_cmp_lt_u32 s6, 24
    s_cselect_b32 s70, s70, s67
    s_lshl_b32 s70, s70, 8
    s_bfe_u32 s71, s6, 0x30001
    s_min_u32 s71, s71, 4
    s_mul_i32 s67, s5, 5
    s_add_u32 s71, s71, s67
    s_cmp_lt_u32 s6, 28
    s_cbranch_scc1 L_rmt_140
    s_lshl3_add_u32 s71, s5, 3
    s_cmp_lt_u32 s5, 6
    s_cbranch_scc1 L_rmt_141
    s_add_u32 s71, s5, 34
L_rmt_140:
    s_add_u32 s67, s71, 4
    s_mul_i32 s67, s67, 37
    s_lshr_b32 s67, s67, 8
    s_add_u32 s71, s71, s67
L_rmt_141:
    s_mul_i32 s66, s70, 12288
    s_lshl_b32 s71, s71, 7
    s_add_u32 s66, s66, s71
    s_add_u32 s66, s66, 4096
    s_cmp_ge_u32 s6, 24
    s_cbranch_scc1 L_lr3
    s_mov_b32 s80, 160000
L_lw_142:
    ds_read_b32 v16, v14 offset:88
    s_waitcnt lgkmcnt(0)
    v_cmp_le_i32 vcc, 8, v16
    s_sub_u32 s80, s80, 1
    s_cbranch_vccnz L_lwd_143
    s_cmp_lg_u32 s80, 0
    s_cbranch_scc1 L_lw_142
L_lwd_143:
L_lwe_144:
    v_mul_u32_u24 v24, 12288, v8
    v_add_u32 v24, v24, v9
    v_add_u32 v25, 97280, v24
    v_add_u32 v26, 194560, v24
    v_add_u32 v27, 291840, v24
    v_add_u32 v28, 393216, v24
    v_add_u32 v29, 490496, v24
    v_add_u32 v30, 587776, v24
    v_add_u32 v31, 685056, v24
    s_mov_b32 s75, -3
L_seg_147:
    s_mov_b32 m0, s73
    s_waitcnt vmcnt(12)
    buffer_load_dwordx4 v24, s[44:47], s66 offen offset:0 nt lds
    buffer_load_dwordx4 v25, s[44:47], s66 offen offset:1024 nt lds
    buffer_load_dwordx4 v26, s[44:47], s66 offen offset:2048 nt lds
    buffer_load_dwordx4 v27, s[44:47], s66 offen offset:3072 nt lds
    s_add_u32 m0, s73, 4096
    s_waitcnt vmcnt(12)
    s_sub_u32 s67, s72, 1
    v_mov_b32 v20, s67
    ds_max_i32 v19, v20 offset:0
    buffer_load_dwordx4 v28, s[44:47], s66 offen offset:0 nt lds
    s_add_u32 s73, s73, 8192
    buffer_load_dwordx4 v29, s[44:47], s66 offen offset:1024 nt lds
    buffer_load_dwordx4 v30, s[44:47], s66 offen offset:2048 nt lds
    s_add_u32 s72, s72, 1
    buffer_load_dwordx4 v31, s[44:47], s66 offen offset:3072 nt lds
    s_add_u32 s66, s66, 786432
    s_add_u32 s75, s75, 1
    s_cbranch_scc0 L_seg_147
    s_mov_b32 s75, -5
L_seg_150:
    s_mov_b32 m0, s73
    s_waitcnt vmcnt(52)
    buffer_load_dwordx4 v24, s[44:47], s66 offen offset:0 nt lds
    buffer_load_dwordx4 v25, s[44:47], s66 offen offset:1024 nt lds
    buffer_load_dwordx4 v26, s[44:47], s66 offen offset:2048 nt lds
    buffer_load_dwordx4 v27, s[44:47], s66 offen offset:3072 nt lds
    s_add_u32 m0, s73, 4096
    s_waitcnt vmcnt(52)
    s_sub_u32 s67, s72, 6
    v_mov_b32 v20, s67
    ds_max_i32 v19, v20 offset:0
    buffer_load_dwordx4 v28, s[44:47], s66 offen offset:0 nt lds
    s_add_u32 s73, s73, 8192
    s_cmp_ge_u32 s73, 131072
    s_cselect_b32 s73, 0, s73
    s_cselect_b32 s67, 8, 0
    s_add_u32 s74, s74, s67
    buffer_load_dwordx4 v29, s[44:47], s66 offen offset:1024 nt lds
    buffer_load_dwordx4 v30, s[44:47], s66 offen offset:2048 nt lds
    s_add_u32 s72, s72, 1
    buffer_load_dwordx4 v31, s[44:47], s66 offen offset:3072 nt lds
    s_add_u32 s66, s66, 786432
    s_add_u32 s75, s75, 1
    s_cbranch_scc0 L_seg_150
    s_lshr_b32 s66, s5, 1
    s_lshl_b32 s66, s66, 21
    s_and_b32 s67, s5, 1
    s_lshl_b32 s67, s67, 17
    s_add_u32 s66, s66, s67
    s_sub_u32 s69, s6, 16
    s_cmp_eq_u32 s6, 19
    s_cselect_b32 s69, 9, s69
    s_cmp_eq_u32 s6, 25
    s_cselect_b32 s69, 3, s69
    s_lshl_b32 s69, s69, 7
    s_add_u32 s66, s66, s69
    v_mul_u32_u24 v24, 2048, v8
    v_add_u32 v24, v24, v9
    v_add_u32 v25, 261120, v24
    v_add_u32 v26, 522240, v24
    v_add_u32 v27, 783360, v24
    v_add_u32 v28, 1048576, v24
    v_add_u32 v29, 1309696, v24
    v_add_u32 v30, 1570816, v24
    v_add_u32 v31, 1831936, v24
    s_mov_b32 s75, -8
    s_lshr_b32 s67, s73, 11
    v_add_u32 v22, s67, v14
    ds_read_b32 v21, v22 offset:4
L_seg_153:
    s_waitcnt lgkmcnt(0)
    v_cmp_le_i32 vcc, s74, v21
    s_cbranch_vccnz L_cok_154
    ds_read_b32 v21, v22 offset:4
    s_waitcnt lgkmcnt(0)
    v_cmp_le_i32 vcc, s74, v21
    s_cbranch_vccnz L_cok_154
    s_waitcnt vmcnt(0)
    s_sub_u32 s67, s72, 0
    v_mov_b32 v20, s67
    ds_max_i32 v19, v20 offset:0
    s_mov_b32 s80, 160000
L_csp_155:
    ds_read_b32 v21, v22 offset:4
    s_waitcnt lgkmcnt(0)
    v_cmp_le_i32 vcc, s74, v21
    s_sub_u32 s80, s80, 1
    s_cbranch_vccnz L_cok_154
    s_cmp_lg_u32 s80, 0
    s_cbranch_scc1 L_csp_155
L_cok_154:
    s_mov_b32 m0, s73
    s_waitcnt vmcnt(52)
    buffer_load_dwordx4 v24, s[24:27], s66 offen offset:0 nt lds
    buffer_load_dwordx4 v25, s[24:27], s66 offen offset:1024 nt lds
    buffer_load_dwordx4 v26, s[24:27], s66 offen offset:2048 nt lds
    buffer_load_dwordx4 v27, s[24:27], s66 offen offset:3072 nt lds
    s_add_u32 m0, s73, 4096
    s_waitcnt vmcnt(52)
    s_sub_u32 s67, s72, 6
    v_mov_b32 v20, s67
    ds_max_i32 v19, v20 offset:0
    buffer_load_dwordx4 v28, s[24:27], s66 offen offset:0 nt lds
    s_add_u32 s73, s73, 8192
    s_cmp_ge_u32 s73, 131072
    s_cselect_b32 s73, 0, s73
    s_cselect_b32 s67, 8, 0
    s_add_u32 s74, s74, s67
    buffer_load_dwordx4 v29, s[24:27], s66 offen offset:1024 nt lds
    s_lshr_b32 s67, s73, 11
    v_add_u32 v22, s67, v14
    ds_read_b32 v21, v22 offset:4
    buffer_load_dwordx4 v30, s[24:27], s66 offen offset:2048 nt lds
    s_add_u32 s72, s72, 1
    buffer_load_dwordx4 v31, s[24:27], s66 offen offset:3072 nt lds
    s_add_u32 s66, s66, 16384
    s_add_u32 s75, s75, 1
    s_cbranch_scc0 L_seg_153
    s_waitcnt vmcnt(48)
    s_sub_u32 s67, s72, 6
    v_mov_b32 v20, s67
    ds_max_i32 v19, v20 offset:0
    s_waitcnt vmcnt(40)
    s_sub_u32 s67, s72, 5
    v_mov_b32 v20, s67
    ds_max_i32 v19, v20 offset:0
    s_waitcnt vmcnt(32)
    s_sub_u32 s67, s72, 4
    v_mov_b32 v20, s67
    ds_max_i32 v19, v20 offset:0
    s_waitcnt vmcnt(24)
    s_sub_u32 s67, s72, 3
    v_mov_b32 v20, s67
    ds_max_i32 v19, v20 offset:0
    s_waitcnt vmcnt(16)
    s_sub_u32 s67, s72, 2
    v_mov_b32 v20, s67
    ds_max_i32 v19, v20 offset:0
    s_waitcnt vmcnt(8)
    s_sub_u32 s67, s72, 1
    v_mov_b32 v20, s67
    ds_max_i32 v19, v20 offset:0
    s_waitcnt vmcnt(0)
    s_sub_u32 s67, s72, 0
    v_mov_b32 v20, s67
    ds_max_i32 v19, v20 offset:0
    s_mov_b32 s80, 160000
L_lw_156:
    ds_read_b32 v16, v14 offset:112
    s_waitcnt lgkmcnt(0)
    v_cmp_le_i32 vcc, 8, v16
    s_sub_u32 s80, s80, 1
    s_cbranch_vccnz L_lwd_157
    s_cmp_lg_u32 s80, 0
    s_cbranch_scc1 L_lw_156
L_lwd_157:
L_lwe_158:
    s_mul_i32 s66, s5, 917504
    s_sub_u32 s69, s6, 16
    s_cmp_eq_u32 s6, 21
    s_cselect_b32 s69, 11, s69
    s_cmp_eq_u32 s6, 27
    s_cselect_b32 s69, 5, s69
    s_lshl_b32 s69, s69, 7
    s_add_u32 s66, s66, s69
    v_mul_u32_u24 v24, 2048, v8
    v_add_u32 v24, v24, v9
    v_add_u32 v25, 15360, v24
    v_add_u32 v26, 30720, v24
    v_add_u32 v27, 46080, v24
    v_add_u32 v28, 65536, v24
    v_add_u32 v29, 80896, v24
    v_add_u32 v30, 96256, v24
    v_add_u32 v31, 111616, v24
    s_mov_b32 s75, -7
    s_lshr_b32 s67, s73, 11
    v_add_u32 v22, s67, v14
    ds_read_b32 v21, v22 offset:4
L_seg_161:
    s_waitcnt lgkmcnt(0)
    v_cmp_le_i32 vcc, s74, v21
    s_cbranch_vccnz L_cok_162
    ds_read_b32 v21, v22 offset:4
    s_waitcnt lgkmcnt(0)
    v_cmp_le_i32 vcc, s74, v21
    s_cbranch_vccnz L_cok_162
    s_waitcnt vmcnt(0)
    s_sub_u32 s67, s72, 0
    v_mov_b32 v20, s67
    ds_max_i32 v19, v20 offset:0
    s_mov_b32 s80, 160000
L_csp_163:
    ds_read_b32 v21, v22 offset:4
    s_waitcnt lgkmcnt(0)
    v_cmp_le_i32 vcc, s74, v21
    s_sub_u32 s80, s80, 1
    s_cbranch_vccnz L_cok_162
    s_cmp_lg_u32 s80, 0
    s_cbranch_scc1 L_csp_163
L_cok_162:
    s_mov_b32 m0, s73
    s_waitcnt vmcnt(52)
    buffer_load_dwordx4 v24, s[36:39], s66 offen offset:0 nt lds
    buffer_load_dwordx4 v25, s[36:39], s66 offen offset:1024 nt lds
    buffer_load_dwordx4 v26, s[36:39], s66 offen offset:2048 nt lds
    buffer_load_dwordx4 v27, s[36:39], s66 offen offset:3072 nt lds
    s_add_u32 m0, s73, 4096
    s_waitcnt vmcnt(52)
    s_sub_u32 s67, s72, 6
    v_mov_b32 v20, s67
    ds_max_i32 v19, v20 offset:0
    buffer_load_dwordx4 v28, s[36:39], s66 offen offset:0 nt lds
    s_add_u32 s73, s73, 8192
    s_cmp_ge_u32 s73, 131072
    s_cselect_b32 s73, 0, s73
    s_cselect_b32 s67, 8, 0
    s_add_u32 s74, s74, s67
    buffer_load_dwordx4 v29, s[36:39], s66 offen offset:1024 nt lds
    s_lshr_b32 s67, s73, 11
    v_add_u32 v22, s67, v14
    ds_read_b32 v21, v22 offset:4
    buffer_load_dwordx4 v30, s[36:39], s66 offen offset:2048 nt lds
    s_add_u32 s72, s72, 1
    buffer_load_dwordx4 v31, s[36:39], s66 offen offset:3072 nt lds
    s_add_u32 s66, s66, 131072
    s_add_u32 s75, s75, 1
    s_cbranch_scc0 L_seg_161
    s_waitcnt vmcnt(48)
    s_sub_u32 s67, s72, 6
    v_mov_b32 v20, s67
    ds_max_i32 v19, v20 offset:0
    s_waitcnt vmcnt(40)
    s_sub_u32 s67, s72, 5
    v_mov_b32 v20, s67
    ds_max_i32 v19, v20 offset:0
    s_waitcnt vmcnt(32)
    s_sub_u32 s67, s72, 4
    v_mov_b32 v20, s67
    ds_max_i32 v19, v20 offset:0
    s_waitcnt vmcnt(24)
    s_sub_u32 s67, s72, 3
    v_mov_b32 v20, s67
    ds_max_i32 v19, v20 offset:0
    s_waitcnt vmcnt(16)
    s_sub_u32 s67, s72, 2
    v_mov_b32 v20, s67
    ds_max_i32 v19, v20 offset:0
    s_waitcnt vmcnt(8)
    s_sub_u32 s67, s72, 1
    v_mov_b32 v20, s67
    ds_max_i32 v19, v20 offset:0
    s_waitcnt vmcnt(0)
    s_sub_u32 s67, s72, 0
    v_mov_b32 v20, s67
    ds_max_i32 v19, v20 offset:0
    s_branch L_done
L_lr3:
    v_mov_b32 v20, 8
    v_lshl_add_u32 v22, v1, 2, v14
    s_mov_b64 exec, 15
    ds_add_u32 v22, v20 offset:36
    s_mov_b64 exec, -1
    s_mov_b32 s72, 12
    s_mov_b32 s73, 98304
    s_mov_b32 s80, 160000
L_lw_164:
    ds_read_b32 v16, v14 offset:88
    s_waitcnt lgkmcnt(0)
    v_cmp_le_i32 vcc, 8, v16
    s_sub_u32 s80, s80, 1
    s_cbranch_vccnz L_lwd_165
    s_cmp_lg_u32 s80, 0
    s_cbranch_scc1 L_lw_164
L_lwd_165:
L_lwe_166:
    v_mul_u32_u24 v24, 12288, v8
    v_add_u32 v24, v24, v9
    v_add_u32 v25, 97280, v24
    v_add_u32 v26, 194560, v24
    v_add_u32 v27, 291840, v24
    v_add_u32 v28, 393216, v24
    v_add_u32 v29, 490496, v24
    v_add_u32 v30, 587776, v24
    v_add_u32 v31, 685056, v24
    s_mov_b32 s75, -3
L_seg_169:
    s_mov_b32 m0, s73
    s_waitcnt vmcnt(12)
    buffer_load_dwordx4 v24, s[44:47], s66 offen offset:0 nt lds
    buffer_load_dwordx4 v25, s[44:47], s66 offen offset:1024 nt lds
    buffer_load_dwordx4 v26, s[44:47], s66 offen offset:2048 nt lds
    buffer_load_dwordx4 v27, s[44:47], s66 offen offset:3072 nt lds
    s_add_u32 m0, s73, 4096
    s_waitcnt vmcnt(12)
    s_sub_u32 s67, s72, 1
    v_mov_b32 v20, s67
    ds_max_i32 v19, v20 offset:0
    buffer_load_dwordx4 v28, s[44:47], s66 offen offset:0 nt lds
    s_add_u32 s73, s73, 8192
    buffer_load_dwordx4 v29, s[44:47], s66 offen offset:1024 nt lds
    buffer_load_dwordx4 v30, s[44:47], s66 offen offset:2048 nt lds
    s_add_u32 s72, s72, 1
    buffer_load_dwordx4 v31, s[44:47], s66 offen offset:3072 nt lds
    s_add_u32 s66, s66, 786432
    s_add_u32 s75, s75, 1
    s_cbranch_scc0 L_seg_169
L_seg_172:
    s_mov_b32 m0, s73
    s_waitcnt vmcnt(52)
    buffer_load_dwordx4 v24, s[44:47], s66 offen offset:0 nt lds
    buffer_load_dwordx4 v25, s[44:47], s66 offen offset:1024 nt lds
    buffer_load_dwordx4 v26, s[44:47], s66 offen offset:2048 nt lds
    buffer_load_dwordx4 v27, s[44:47], s66 offen offset:3072 nt lds
    s_add_u32 m0, s73, 4096
    s_waitcnt vmcnt(52)
    s_sub_u32 s67, s72, 6
    v_mov_b32 v20, s67
    ds_max_i32 v19, v20 offset:0
    buffer_load_dwordx4 v28, s[44:47], s66 offen offset:0 nt lds
    s_add_u32 s73, s73, 8192
    s_cmp_ge_u32 s73, 131072
    s_cselect_b32 s73, 0, s73
    s_cselect_b32 s67, 8, 0
    s_add_u32 s74, s74, s67
    buffer_load_dwordx4 v29, s[44:47], s66 offen offset:1024 nt lds
    buffer_load_dwordx4 v30, s[44:47], s66 offen offset:2048 nt lds
    s_add_u32 s72, s72, 1
    buffer_load_dwordx4 v31, s[44:47], s66 offen offset:3072 nt lds
    s_add_u32 s66, s66, 786432
    s_lshr_b32 s66, s5, 1
    s_lshl_b32 s66, s66, 21
    s_and_b32 s67, s5, 1
    s_lshl_b32 s67, s67, 17
    s_add_u32 s66, s66, s67
    s_sub_u32 s69, s6, 16
    s_cmp_eq_u32 s6, 19
    s_cselect_b32 s69, 9, s69
    s_cmp_eq_u32 s6, 25
    s_cselect_b32 s69, 3, s69
    s_lshl_b32 s69, s69, 7
    s_add_u32 s66, s66, s69
    v_mul_u32_u24 v24, 2048, v8
    v_add_u32 v24, v24, v9
    v_add_u32 v25, 261120, v24
    v_add_u32 v26, 522240, v24
    v_add_u32 v27, 783360, v24
    v_add_u32 v28, 1048576, v24
    v_add_u32 v29, 1309696, v24
    v_add_u32 v30, 1570816, v24
    v_add_u32 v31, 1831936, v24
    s_mov_b32 s75, -8
    s_lshr_b32 s67, s73, 11
    v_add_u32 v22, s67, v14
    ds_read_b32 v21, v22 offset:4
L_seg_175:
    s_waitcnt lgkmcnt(0)
    v_cmp_le_i32 vcc, s74, v21
    s_cbranch_vccnz L_cok_176
    ds_read_b32 v21, v22 offset:4
    s_waitcnt lgkmcnt(0)
    v_cmp_le_i32 vcc, s74, v21
    s_cbranch_vccnz L_cok_176
    s_waitcnt vmcnt(0)
    s_sub_u32 s67, s72, 0
    v_mov_b32 v20, s67
    ds_max_i32 v19, v20 offset:0
    s_mov_b32 s80, 160000
L_csp_177:
    ds_read_b32 v21, v22 offset:4
    s_waitcnt lgkmcnt(0)
    v_cmp_le_i32 vcc, s74, v21
    s_sub_u32 s80, s80, 1
    s_cbranch_vccnz L_cok_176
    s_cmp_lg_u32 s80, 0
    s_cbranch_scc1 L_csp_177
L_cok_176:
    s_mov_b32 m0, s73
    s_waitcnt vmcnt(52)
    buffer_load_dwordx4 v24, s[24:27], s66 offen offset:0 nt lds
    buffer_load_dwordx4 v25, s[24:27], s66 offen offset:1024 nt lds
    buffer_load_dwordx4 v26, s[24:27], s66 offen offset:2048 nt lds
    buffer_load_dwordx4 v27, s[24:27], s66 offen offset:3072 nt lds
    s_add_u32 m0, s73, 4096
    s_waitcnt vmcnt(52)
    s_sub_u32 s67, s72, 6
    v_mov_b32 v20, s67
    ds_max_i32 v19, v20 offset:0
    buffer_load_dwordx4 v28, s[24:27], s66 offen offset:0 nt lds
    s_add_u32 s73, s73, 8192
    s_cmp_ge_u32 s73, 131072
    s_cselect_b32 s73, 0, s73
    s_cselect_b32 s67, 8, 0
    s_add_u32 s74, s74, s67
    buffer_load_dwordx4 v29, s[24:27], s66 offen offset:1024 nt lds
    s_lshr_b32 s67, s73, 11
    v_add_u32 v22, s67, v14
    ds_read_b32 v21, v22 offset:4
    buffer_load_dwordx4 v30, s[24:27], s66 offen offset:2048 nt lds
    s_add_u32 s72, s72, 1
    buffer_load_dwordx4 v31, s[24:27], s66 offen offset:3072 nt lds
    s_add_u32 s66, s66, 16384
    s_add_u32 s75, s75, 1
    s_cbranch_scc0 L_seg_175
    s_mul_i32 s66, s5, 917504
    s_sub_u32 s69, s6, 16
    s_cmp_eq_u32 s6, 21
    s_cselect_b32 s69, 11, s69
    s_cmp_eq_u32 s6, 27
    s_cselect_b32 s69, 5, s69
    s_lshl_b32 s69, s69, 7
    s_add_u32 s66, s66, s69
    v_mul_u32_u24 v24, 2048, v8
    v_add_u32 v24, v24, v9
    v_add_u32 v25, 15360, v24
    v_add_u32 v26, 30720, v24
    v_add_u32 v27, 46080, v24
    v_add_u32 v28, 65536, v24
    v_add_u32 v29, 80896, v24
    v_add_u32 v30, 96256, v24
    v_add_u32 v31, 111616, v24
    s_waitcnt vmcnt(48)
    s_sub_u32 s67, s72, 6
    v_mov_b32 v20, s67
    ds_max_i32 v19, v20 offset:0
    s_waitcnt vmcnt(40)
    s_sub_u32 s67, s72, 5
    v_mov_b32 v20, s67
    ds_max_i32 v19, v20 offset:0
    s_waitcnt vmcnt(32)
    s_sub_u32 s67, s72, 4
    v_mov_b32 v20, s67
    ds_max_i32 v19, v20 offset:0
    s_waitcnt vmcnt(24)
    s_sub_u32 s67, s72, 3
    v_mov_b32 v20, s67
    ds_max_i32 v19, v20 offset:0
    s_waitcnt vmcnt(16)
    s_sub_u32 s67, s72, 2
    v_mov_b32 v20, s67
    ds_max_i32 v19, v20 offset:0
    s_waitcnt vmcnt(8)
    s_sub_u32 s67, s72, 1
    v_mov_b32 v20, s67
    ds_max_i32 v19, v20 offset:0
    s_waitcnt vmcnt(0)
    s_sub_u32 s67, s72, 0
    v_mov_b32 v20, s67
    ds_max_i32 v19, v20 offset:0
    s_mov_b32 s80, 160000
L_lw_178:
    ds_read_b32 v16, v14 offset:120
    s_waitcnt lgkmcnt(0)
    v_cmp_le_i32 vcc, 8, v16
    s_sub_u32 s80, s80, 1
    s_cbranch_vccnz L_lwd_179
    s_cmp_lg_u32 s80, 0
    s_cbranch_scc1 L_lw_178
L_lwd_179:
L_lwe_180:
    s_mov_b32 s75, -7
    s_lshr_b32 s67, s73, 11
    v_add_u32 v22, s67, v14
    ds_read_b32 v21, v22 offset:4
L_seg_183:
    s_waitcnt lgkmcnt(0)
    v_cmp_le_i32 vcc, s74, v21
    s_cbranch_vccnz L_cok_184
    ds_read_b32 v21, v22 offset:4
    s_waitcnt lgkmcnt(0)
    v_cmp_le_i32 vcc, s74, v21
    s_cbranch_vccnz L_cok_184
    s_waitcnt vmcnt(0)
    s_sub_u32 s67, s72, 0
    v_mov_b32 v20, s67
    ds_max_i32 v19, v20 offset:0
    s_mov_b32 s80, 160000
L_csp_185:
    ds_read_b32 v21, v22 offset:4
    s_waitcnt lgkmcnt(0)
    v_cmp_le_i32 vcc, s74, v21
    s_sub_u32 s80, s80, 1
    s_cbranch_vccnz L_cok_184
    s_cmp_lg_u32 s80, 0
    s_cbranch_scc1 L_csp_185
L_cok_184:
    s_mov_b32 m0, s73
    s_waitcnt vmcnt(52)
    buffer_load_dwordx4 v24, s[36:39], s66 offen offset:0 nt lds
    buffer_load_dwordx4 v25, s[36:39], s66 offen offset:1024 nt lds
    buffer_load_dwordx4 v26, s[36:39], s66 offen offset:2048 nt lds
    buffer_load_dwordx4 v27, s[36:39], s66 offen offset:3072 nt lds
    s_add_u32 m0, s73, 4096
    s_waitcnt vmcnt(52)
    s_sub_u32 s67, s72, 6
    v_mov_b32 v20, s67
    ds_max_i32 v19, v20 offset:0
    buffer_load_dwordx4 v28, s[36:39], s66 offen offset:0 nt lds
    s_add_u32 s73, s73, 8192
    s_cmp_ge_u32 s73, 131072
    s_cselect_b32 s73, 0, s73
    s_cselect_b32 s67, 8, 0
    s_add_u32 s74, s74, s67
    buffer_load_dwordx4 v29, s[36:39], s66 offen offset:1024 nt lds
    s_lshr_b32 s67, s73, 11
    v_add_u32 v22, s67, v14
    ds_read_b32 v21, v22 offset:4
    buffer_load_dwordx4 v30, s[36:39], s66 offen offset:2048 nt lds
    s_add_u32 s72, s72, 1
    buffer_load_dwordx4 v31, s[36:39], s66 offen offset:3072 nt lds
    s_add_u32 s66, s66, 131072
    s_add_u32 s75, s75, 1
    s_cbranch_scc0 L_seg_183
    s_waitcnt vmcnt(48)
    s_sub_u32 s67, s72, 6
    v_mov_b32 v20, s67
    ds_max_i32 v19, v20 offset:0
    s_waitcnt vmcnt(40)
    s_sub_u32 s67, s72, 5
    v_mov_b32 v20, s67
    ds_max_i32 v19, v20 offset:0
    s_waitcnt vmcnt(32)
    s_sub_u32 s67, s72, 4
    v_mov_b32 v20, s67
    ds_max_i32 v19, v20 offset:0
    s_waitcnt vmcnt(24)
    s_sub_u32 s67, s72, 3
    v_mov_b32 v20, s67
    ds_max_i32 v19, v20 offset:0
    s_waitcnt vmcnt(16)
    s_sub_u32 s67, s72, 2
    v_mov_b32 v20, s67
    ds_max_i32 v19, v20 offset:0
    s_waitcnt vmcnt(8)
    s_sub_u32 s67, s72, 1
    v_mov_b32 v20, s67
    ds_max_i32 v19, v20 offset:0
    s_waitcnt vmcnt(0)
    s_sub_u32 s67, s72, 0
    v_mov_b32 v20, s67
    ds_max_i32 v19, v20 offset:0
    s_branch L_done
L_att:
    s_mov_b32 s68, s6
    s_and_b32 s72, s68, 3
    s_and_b32 s73, s5, 1
    s_lshl_b32 s73, s73, 2
    s_lshr_b32 s67, s68, 2
    s_add_u32 s73, s73, s67
    s_mov_b32 s74, s65
    v_and_b32 v8, 31, v1
    v_lshrrev_b32 v16, 5, v1
    v_sub_u32 v61, 1, v16
    v_add_u32 v16, s5, v16
    v_add_u32 v17, 0, v16
    v_and_b32 v17, 7, v17
    v_lshlrev_b32 v17, 17, v17
    v_lshl_add_u32 v60, v8, 4, v17
    v_add_u32 v17, 2, v16
    v_and_b32 v17, 7, v17
    v_lshlrev_b32 v17, 17, v17
    v_lshl_add_u32 v57, v8, 4, v17
    v_add_u32 v17, 4, v16
    v_and_b32 v17, 7, v17
    v_lshlrev_b32 v17, 17, v17
    v_lshl_add_u32 v58, v8, 4, v17
    v_add_u32 v17, 6, v16
    v_and_b32 v17, 7, v17
    v_lshlrev_b32 v17, 17, v17
    v_lshl_add_u32 v59, v8, 4, v17
    v_lshl_add_u32 v56, v61, 22, v60
    s_lshl_b32 s66, s73, 14
    s_lshl_b32 s67, s74, 12
    s_add_u32 s66, s66, s67
    s_lshl_b32 s67, s3, 9
    s_add_u32 s66, s66, s67
    s_add_u32 s66, s66, 659456
    s_mul_i32 s67, s3, 272
    v_lshl_add_u32 v28, v8, 3, v14
    v_add_u32 v28, s67, v28
    v_lshrrev_b32 v16, 5, v1
    v_lshl_add_u32 v28, v16, 2, v28
    v_mul_u32_u24 v29, 272, v4
    v_lshl_add_u32 v29, v2, 4, v29
    v_add_u32 v29, v29, v14
    v_lshl_add_u32 v30, v4, 4, v14
    v_lshl_add_u32 v30, v2, 7, v30
    s_lshl_b32 s67, s3, 9
    v_add_u32 v31, s67, v30
    v_lshl_add_u32 v31, v5, 3, v31
    v_mul_u32_u24 v26, 80, v4
    v_add_u32 v26, v26, v14
    s_lshl_b32 s67, s3, 3
    v_add_u32 v27, s67, v26
    v_lshl_add_u32 v26, v5, 5, v26
    v_mov_b32 v128, 0
    v_mov_b32 v129, 0
    v_mov_b32 v130, 0
    v_mov_b32 v131, 0
    v_mov_b32 v132, 0
    v_mov_b32 v133, 0
    v_mov_b32 v134, 0
    v_mov_b32 v135, 0
    v_mov_b32 v136, 0
    v_mov_b32 v137, 0
    v_mov_b32 v138, 0
    v_mov_b32 v139, 0
    v_mov_b32 v140, 0
    v_mov_b32 v141, 0
    v_mov_b32 v142, 0
    v_mov_b32 v143, 0
    v_mov_b32 v144, 0
    v_mov_b32 v145, 0
    v_mov_b32 v146, 0
    v_mov_b32 v147, 0
    v_mov_b32 v148, 0
    v_mov_b32 v149, 0
    v_mov_b32 v150, 0
    v_mov_b32 v151, 0
    v_mov_b32 v152, 0
    v_mov_b32 v153, 0
    v_mov_b32 v154, 0
    v_mov_b32 v155, 0
    v_mov_b32 v156, 0
    v_mov_b32 v157, 0
    v_mov_b32 v158, 0
    v_mov_b32 v159, 0
    s_not_b64 s[86:87], s[84:85]
    s_lshl_b32 s75, s73, 2
    s_add_u32 s75, s75, s72
    s_lshl_b32 s76, s73, 7
    s_lshl2_add_u32 s76, s72, s76
    s_lshl_b32 s75, s75, 14
    s_lshl_b32 s67, s74, 12
    s_add_u32 s75, s75, s67
    s_lshl_b32 s67, s3, 9
    s_add_u32 s75, s75, s67
    s_add_u32 s75, s75, 1708032
    s_lshl_b32 s67, s74, 10
    s_add_u32 s76, s76, s67
    s_add_u32 s76, s76, 2232320
    s_add_u32 s89, s76, 1298432
    s_cmp_eq_u32 s3, 7
    s_cselect_b32 s92, 1, -1
    s_cselect_b32 s93, 0, -1
    v_sub_u32 v10, v30, v14
    v_lshrrev_b32 v16, 2, v1
    v_and_b32 v17, 7, v16
    v_xor_b32 v17, s3, v17
    v_lshlrev_b32 v16, 8, v16
    v_lshl_add_u32 v16, v17, 5, v16
    v_and_b32 v17, 3, v1
    v_lshl_add_u32 v62, v17, 3, v16
    v_add_u32 v63, 0x10000, v62
    s_add_u32 s78, s3, 4
    s_add_u32 s79, s78, 1
    s_and_b32 s78, s78, 15
    s_lshl_b32 s78, s78, 13
    v_xor_b32 v16, v2, v3
    v_lshlrev_b32 v16, 4, v16
    v_lshl_add_u32 v16, v3, 8, v16
    v_xor_b32 v17, 0, v16
    v_add_u32 v164, s78, v17
    v_xor_b32 v17, 64, v16
    v_add_u32 v165, s78, v17
    v_xor_b32 v17, 128, v16
    v_add_u32 v166, s78, v17
    v_xor_b32 v17, 192, v16
    v_add_u32 v167, s78, v17
    s_mov_b32 s80, 160000
L_lw_186:
    ds_read_b32 v16, v14 offset:0
    s_waitcnt lgkmcnt(0)
    v_cmp_le_i32 vcc, s79, v16
    s_sub_u32 s80, s80, 1
    s_cbranch_vccnz L_lwd_187
    s_nop 15
    s_nop 15
    s_nop 15
    s_cmp_lg_u32 s80, 0
    s_cbranch_scc1 L_lw_186
L_lwd_187:
L_lwe_188:
    ds_read_b128 v[64:67], v164 offset:0
    ds_read_b128 v[68:71], v165 offset:0
    ds_read_b128 v[72:75], v166 offset:0
    ds_read_b128 v[76:79], v167 offset:0
    ds_read_b128 v[80:83], v164 offset:4096
    ds_read_b128 v[84:87], v165 offset:4096
    ds_read_b128 v[88:91], v166 offset:4096
    ds_read_b128 v[92:95], v167 offset:4096
    s_waitcnt lgkmcnt(0)
    s_lshr_b32 s67, s78, 11
    v_add_u32 v16, s67, v14
    v_mov_b32 v17, 8
    s_mov_b64 exec, 1
    ds_add_u32 v16, v17 offset:4
    s_mov_b64 exec, -1
    s_mov_b32 s77, 0
    s_mov_b32 exec_lo, 0x1
    s_mov_b32 exec_hi, 0x1
    s_mov_b32 s80, 20007
L_poll_189:
    buffer_load_dword v25, v58, s[52:55], s66 offen sc1
    s_cmp_lg_u32 s77, 0
    s_cbranch_scc1 L_hk_191
    ds_read_b32 v16, v14 offset:0
    s_waitcnt lgkmcnt(0)
    v_cmp_le_i32 vcc, 20, v16
    s_cbranch_vccz L_hk_191
    s_mov_b64 exec, -1
    ds_read_b64_tr_b16 v[96:97], v63 offset:32768
    ds_read_b64_tr_b16 v[98:99], v63 offset:36864
    ds_read_b64_tr_b16 v[100:101], v63 offset:40960
    ds_read_b64_tr_b16 v[102:103], v63 offset:45056
    ds_read_b64_tr_b16 v[104:105], v63 offset:49152
    ds_read_b64_tr_b16 v[106:107], v63 offset:53248
    ds_read_b64_tr_b16 v[108:109], v63 offset:57344
    ds_read_b64_tr_b16 v[110:111], v63 offset:61440
    ds_read_b64_tr_b16 v[112:113], v62 offset:0
    ds_read_b64_tr_b16 v[114:115], v62 offset:4096
    ds_read_b64_tr_b16 v[116:117], v62 offset:8192
    ds_read_b64_tr_b16 v[118:119], v62 offset:12288
    ds_read_b64_tr_b16 v[120:121], v62 offset:16384
    ds_read_b64_tr_b16 v[122:123], v62 offset:20480
    ds_read_b64_tr_b16 v[124:125], v62 offset:24576
    ds_read_b64_tr_b16 v[126:127], v62 offset:28672
    s_mov_b32 exec_lo, 0x1
    s_mov_b32 exec_hi, 0x1
    s_mov_b32 s77, 1
L_hk_191:
    s_waitcnt vmcnt(0)
    v_xor_b32 v24, s4, v25
    v_and_b32 v24, v6, v24
    v_cmp_ne_u32 vcc, 0, v24
    s_sub_u32 s80, s80, 1
    s_cbranch_vccz L_pdone_190
    s_cmp_lg_u32 s80, 0
    s_cbranch_scc1 L_poll_189
L_pdone_190:
    s_mov_b64 exec, -1
    buffer_load_dwordx4 v[32:35], v56, s[52:55], s66 offen sc1
    buffer_load_dwordx4 v[36:39], v57, s[52:55], s66 offen sc1
    buffer_load_dwordx4 v[40:43], v58, s[52:55], s66 offen sc1
    buffer_load_dwordx4 v[44:47], v59, s[52:55], s66 offen sc1
    s_cmp_lg_u32 s77, 0
    s_cbranch_scc1 L_hk_194
    ds_read_b32 v16, v14 offset:0
    s_waitcnt lgkmcnt(0)
    v_cmp_le_i32 vcc, 20, v16
    s_cbranch_vccz L_hk_194
    s_mov_b64 exec, -1
    ds_read_b64_tr_b16 v[96:97], v63 offset:32768
    ds_read_b64_tr_b16 v[98:99], v63 offset:36864
    ds_read_b64_tr_b16 v[100:101], v63 offset:40960
    ds_read_b64_tr_b16 v[102:103], v63 offset:45056
    ds_read_b64_tr_b16 v[104:105], v63 offset:49152
    ds_read_b64_tr_b16 v[106:107], v63 offset:53248
    ds_read_b64_tr_b16 v[108:109], v63 offset:57344
    ds_read_b64_tr_b16 v[110:111], v63 offset:61440
    ds_read_b64_tr_b16 v[112:113], v62 offset:0
    ds_read_b64_tr_b16 v[114:115], v62 offset:4096
    ds_read_b64_tr_b16 v[116:117], v62 offset:8192
    ds_read_b64_tr_b16 v[118:119], v62 offset:12288
    ds_read_b64_tr_b16 v[120:121], v62 offset:16384
    ds_read_b64_tr_b16 v[122:123], v62 offset:20480
    ds_read_b64_tr_b16 v[124:125], v62 offset:24576
    ds_read_b64_tr_b16 v[126:127], v62 offset:28672
    s_mov_b32 exec_lo, 0xffffffff
    s_mov_b32 exec_hi, 0xffffffff
    s_mov_b32 s77, 1
L_hk_194:
    s_waitcnt vmcnt(3)
    v_xor_b32 v24, s4, v32
    v_bitop3_b32 v24, v33, v24, s4 bitop3:0xde
    v_bitop3_b32 v24, v34, v24, s4 bitop3:0xde
    v_bitop3_b32 v24, v35, v24, s4 bitop3:0xde
    s_waitcnt vmcnt(2)
    v_bitop3_b32 v24, v36, v24, s4 bitop3:0xde
    v_bitop3_b32 v24, v37, v24, s4 bitop3:0xde
    v_bitop3_b32 v24, v38, v24, s4 bitop3:0xde
    v_bitop3_b32 v24, v39, v24, s4 bitop3:0xde
    s_waitcnt vmcnt(1)
    v_bitop3_b32 v24, v40, v24, s4 bitop3:0xde
    v_bitop3_b32 v24, v41, v24, s4 bitop3:0xde
    v_bitop3_b32 v24, v42, v24, s4 bitop3:0xde
    v_bitop3_b32 v24, v43, v24, s4 bitop3:0xde
    s_waitcnt vmcnt(0)
    v_bitop3_b32 v24, v44, v24, s4 bitop3:0xde
    v_bitop3_b32 v24, v45, v24, s4 bitop3:0xde
    v_bitop3_b32 v24, v46, v24, s4 bitop3:0xde
    v_bitop3_b32 v24, v47, v24, s4 bitop3:0xde
    v_and_b32 v24, v6, v24
    v_cmp_ne_u32 vcc, 0, v24
    s_mov_b32 s80, 20007
    s_cbranch_vccz L_pdone_193
L_poll_192:
    buffer_load_dwordx4 v[32:35], v56, s[52:55], s66 offen sc1
    buffer_load_dwordx4 v[36:39], v57, s[52:55], s66 offen sc1
    buffer_load_dwordx4 v[40:43], v58, s[52:55], s66 offen sc1
    buffer_load_dwordx4 v[44:47], v59, s[52:55], s66 offen sc1
    s_waitcnt vmcnt(3)
    v_xor_b32 v24, s4, v32
    v_bitop3_b32 v24, v33, v24, s4 bitop3:0xde
    v_bitop3_b32 v24, v34, v24, s4 bitop3:0xde
    v_bitop3_b32 v24, v35, v24, s4 bitop3:0xde
    s_waitcnt vmcnt(2)
    v_bitop3_b32 v24, v36, v24, s4 bitop3:0xde
    v_bitop3_b32 v24, v37, v24, s4 bitop3:0xde
    v_bitop3_b32 v24, v38, v24, s4 bitop3:0xde
    v_bitop3_b32 v24, v39, v24, s4 bitop3:0xde
    s_waitcnt vmcnt(1)
    v_bitop3_b32 v24, v40, v24, s4 bitop3:0xde
    v_bitop3_b32 v24, v41, v24, s4 bitop3:0xde
    v_bitop3_b32 v24, v42, v24, s4 bitop3:0xde
    v_bitop3_b32 v24, v43, v24, s4 bitop3:0xde
    s_waitcnt vmcnt(0)
    v_bitop3_b32 v24, v44, v24, s4 bitop3:0xde
    v_bitop3_b32 v24, v45, v24, s4 bitop3:0xde
    v_bitop3_b32 v24, v46, v24, s4 bitop3:0xde
    v_bitop3_b32 v24, v47, v24, s4 bitop3:0xde
    v_and_b32 v24, v6, v24
    v_cmp_ne_u32 vcc, 0, v24
    s_sub_u32 s80, s80, 1
    s_cbranch_vccz L_pdone_193
    s_and_b32 s81, s80, 7
    s_cselect_b32 s81, 4194304, 0
    v_mad_u32_u24 v56, v61, s81, v60
    s_cmp_lg_u32 s80, 0
    s_cbranch_scc1 L_poll_192
L_pdone_193:
    v_add_f32 v32, v32, v36
    v_add_f32 v40, v40, v44
    v_add_f32 v33, v33, v37
    v_add_f32 v41, v41, v45
    v_add_f32 v34, v34, v38
    v_add_f32 v42, v42, v46
    v_add_f32 v35, v35, v39
    v_add_f32 v43, v43, v47
    v_add_f32 v32, v32, v40
    v_add_f32 v33, v33, v41
    v_add_f32 v34, v34, v42
    v_add_f32 v35, v35, v43
    s_nop 0
    v_permlane32_swap_b32 v32, v34
    v_permlane32_swap_b32 v33, v35
    v_add_f32 v32, v32, v34
    v_add_f32 v33, v33, v35
    v_cvt_pk_bf16_f32 v32, v32, v33
    ds_write_b32 v28, v32 offset:512
    s_mov_b64 exec, 1
    ds_add_u32 v14, v15 offset:92
    s_mov_b64 exec, -1
    s_cmp_lg_u32 s77, 0
    s_cbranch_scc1 L_hk_195
    ds_read_b32 v16, v14 offset:0
    s_waitcnt lgkmcnt(0)
    v_cmp_le_i32 vcc, 20, v16
    s_cbranch_vccz L_hk_195
    s_mov_b64 exec, -1
    ds_read_b64_tr_b16 v[96:97], v63 offset:32768
    ds_read_b64_tr_b16 v[98:99], v63 offset:36864
    ds_read_b64_tr_b16 v[100:101], v63 offset:40960
    ds_read_b64_tr_b16 v[102:103], v63 offset:45056
    ds_read_b64_tr_b16 v[104:105], v63 offset:49152
    ds_read_b64_tr_b16 v[106:107], v63 offset:53248
    ds_read_b64_tr_b16 v[108:109], v63 offset:57344
    ds_read_b64_tr_b16 v[110:111], v63 offset:61440
    ds_read_b64_tr_b16 v[112:113], v62 offset:0
    ds_read_b64_tr_b16 v[114:115], v62 offset:4096
    ds_read_b64_tr_b16 v[116:117], v62 offset:8192
    ds_read_b64_tr_b16 v[118:119], v62 offset:12288
    ds_read_b64_tr_b16 v[120:121], v62 offset:16384
    ds_read_b64_tr_b16 v[122:123], v62 offset:20480
    ds_read_b64_tr_b16 v[124:125], v62 offset:24576
    ds_read_b64_tr_b16 v[126:127], v62 offset:28672
    s_mov_b32 exec_lo, 0xffffffff
    s_mov_b32 exec_hi, 0xffffffff
    s_mov_b32 s77, 1
L_hk_195:
    s_mov_b32 s80, 160000
L_lw_196:
    ds_read_b32 v24, v14 offset:92
    ds_read_b128 v[32:35], v29 offset:512
    ds_read_b128 v[36:39], v29 offset:576
    ds_read_b128 v[40:43], v29 offset:640
    ds_read_b128 v[44:47], v29 offset:704
    s_sub_u32 s80, s80, 1
    s_cbranch_scc1 L_lwe_198
    s_waitcnt lgkmcnt(4)
    v_cmp_le_i32 vcc, 8, v24
    s_cbranch_vccz L_lw_196
L_lwe_198:
    s_waitcnt lgkmcnt(3)
    v_mfma_f32_16x16x32_bf16 v[16:19], v[64:67], v[32:35], 0
    v_mfma_f32_16x16x32_bf16 v[20:23], v[80:83], v[32:35], 0
    s_waitcnt lgkmcnt(2)
    v_mfma_f32_16x16x32_bf16 v[16:19], v[68:71], v[36:39], v[16:19]
    v_mfma_f32_16x16x32_bf16 v[20:23], v[84:87], v[36:39], v[20:23]
    s_waitcnt lgkmcnt(1)
    v_mfma_f32_16x16x32_bf16 v[16:19], v[72:75], v[40:43], v[16:19]
    v_mfma_f32_16x16x32_bf16 v[20:23], v[88:91], v[40:43], v[20:23]
    s_waitcnt lgkmcnt(0)
    v_mfma_f32_16x16x32_bf16 v[16:19], v[76:79], v[44:47], v[16:19]
    v_mfma_f32_16x16x32_bf16 v[20:23], v[92:95], v[44:47], v[20:23]
    s_nop 7
    v_cndmask_b32 v16, v20, v16, s[84:85]
    v_cndmask_b32 v17, v21, v17, s[84:85]
    v_cndmask_b32 v18, v22, v18, s[84:85]
    v_cndmask_b32 v19, v23, v19, s[84:85]
    v_cvt_pk_bf16_f32 v24, v16, v17
    v_lshlrev_b32 v16, 16, v24
    v_and_b32 v17, 0xffff0000, v24
    v_cvt_pk_bf16_f32 v25, v18, v19
    v_lshlrev_b32 v18, 16, v25
    v_and_b32 v19, 0xffff0000, v25
    v_mul_f32 v16, 0x3db504f3, v16
    v_mul_f32 v17, 0x3db504f3, v17
    v_mul_f32 v18, 0x3db504f3, v18
    v_mul_f32 v19, 0x3db504f3, v19
    v_cvt_pk_bf16_f32 v24, v16, v17
    v_lshlrev_b32 v16, 16, v24
    v_and_b32 v17, 0xffff0000, v24
    v_cvt_pk_bf16_f32 v25, v18, v19
    v_lshlrev_b32 v18, 16, v25
    v_and_b32 v19, 0xffff0000, v25
    v_max3_f32 v32, v16, v17, v18
    v_max_f32 v33, v32, v19
    s_nop 1
    v_max_f32_dpp v32, v33, v33 row_ror:8 row_mask:0xf bank_mask:0xf
    v_mov_b32 v33, v32
    s_nop 1
    v_permlane16_swap_b32 v32, v33
    v_max_f32 v33, v32, v33
    v_mov_b32 v32, v33
    s_nop 1
    v_permlane32_swap_b32 v32, v33
    v_max_f32 v32, v32, v33
    v_mul_f32 v32, 0x3fb8aa3b, v32
    v_fma_f32 v16, v16, s88, -v32
    v_fma_f32 v17, v17, s88, -v32
    v_fma_f32 v18, v18, s88, -v32
    v_fma_f32 v19, v19, s88, -v32
    v_exp_f32 v16, v16
    v_exp_f32 v17, v17
    v_exp_f32 v18, v18
    v_exp_f32 v19, v19
    v_cvt_pk_bf16_f32 v36, v16, v17
    v_cvt_pk_bf16_f32 v37, v18, v19
    ds_write_b64 v31, v[36:37] offset:2688
    v_add_f32 v16, v16, v17
    v_add_f32 v18, v18, v19
    v_add_f32 v34, v16, v18
    s_nop 1
    v_add_f32_dpp v33, v34, v34 row_ror:8 row_mask:0xf bank_mask:0xf
    v_mov_b32 v34, v33
    s_nop 1
    v_permlane16_swap_b32 v33, v34
    v_add_f32 v34, v33, v34
    v_mov_b32 v33, v34
    s_nop 1
    v_permlane32_swap_b32 v33, v34
    v_add_f32 v33, v33, v34
    ds_write_b64 v27, v[32:33] offset:6784
    s_mov_b64 exec, 1
    ds_add_u32 v14, v15 offset:96
    s_mov_b64 exec, -1
    s_cmp_lg_u32 s77, 0
    s_cbranch_scc1 L_lp_199
    ds_read_b32 v24, v14 offset:0
    ds_read_b64_tr_b16 v[96:97], v63 offset:32768
    ds_read_b64_tr_b16 v[98:99], v63 offset:36864
    ds_read_b64_tr_b16 v[100:101], v63 offset:40960
    ds_read_b64_tr_b16 v[102:103], v63 offset:45056
    ds_read_b64_tr_b16 v[104:105], v63 offset:49152
    ds_read_b64_tr_b16 v[106:107], v63 offset:53248
    ds_read_b64_tr_b16 v[108:109], v63 offset:57344
    ds_read_b64_tr_b16 v[110:111], v63 offset:61440
    ds_read_b64_tr_b16 v[112:113], v62 offset:0
    ds_read_b64_tr_b16 v[114:115], v62 offset:4096
    ds_read_b64_tr_b16 v[116:117], v62 offset:8192
    ds_read_b64_tr_b16 v[118:119], v62 offset:12288
    ds_read_b64_tr_b16 v[120:121], v62 offset:16384
    ds_read_b64_tr_b16 v[122:123], v62 offset:20480
    ds_read_b64_tr_b16 v[124:125], v62 offset:24576
    ds_read_b64_tr_b16 v[126:127], v62 offset:28672
    s_waitcnt lgkmcnt(15)
    v_cmp_le_i32 vcc, 20, v24
    s_cbranch_vccnz L_lwe_202
    s_mov_b32 s80, 160000
L_lw_200:
    ds_read_b32 v24, v14 offset:0
    s_waitcnt lgkmcnt(0)
    v_cmp_le_i32 vcc, 20, v24
    s_sub_u32 s80, s80, 1
    s_cbranch_vccnz L_lwd_201
    s_cmp_lg_u32 s80, 0
    s_cbranch_scc1 L_lw_200
L_lwd_201:
    ds_read_b64_tr_b16 v[96:97], v63 offset:32768
    ds_read_b64_tr_b16 v[98:99], v63 offset:36864
    ds_read_b64_tr_b16 v[100:101], v63 offset:40960
    ds_read_b64_tr_b16 v[102:103], v63 offset:45056
    ds_read_b64_tr_b16 v[104:105], v63 offset:49152
    ds_read_b64_tr_b16 v[106:107], v63 offset:53248
    ds_read_b64_tr_b16 v[108:109], v63 offset:57344
    ds_read_b64_tr_b16 v[110:111], v63 offset:61440
    ds_read_b64_tr_b16 v[112:113], v62 offset:0
    ds_read_b64_tr_b16 v[114:115], v62 offset:4096
    ds_read_b64_tr_b16 v[116:117], v62 offset:8192
    ds_read_b64_tr_b16 v[118:119], v62 offset:12288
    ds_read_b64_tr_b16 v[120:121], v62 offset:16384
    ds_read_b64_tr_b16 v[122:123], v62 offset:20480
    ds_read_b64_tr_b16 v[124:125], v62 offset:24576
    ds_read_b64_tr_b16 v[126:127], v62 offset:28672
L_lwe_202:
L_lp_199:
    ds_read_b32 v24, v14 offset:96
    ds_read_b128 v[32:35], v26 offset:6784
    ds_read_b128 v[36:39], v26 offset:6800
    s_mov_b64 exec, s[84:85]
    ds_read_b128 v[128:131], v30 offset:2688
    ds_read_b128 v[132:135], v30 offset:3200
    ds_read_b128 v[136:139], v30 offset:3712
    ds_read_b128 v[140:143], v30 offset:4224
    s_mov_b64 exec, s[86:87]
    ds_read_b128 v[144:147], v30 offset:4736
    ds_read_b128 v[148:151], v30 offset:5248
    ds_read_b128 v[152:155], v30 offset:5760
    ds_read_b128 v[156:159], v30 offset:6272
    s_mov_b64 exec, -1
    s_waitcnt lgkmcnt(10)
    v_cmp_le_i32 vcc, 8, v24
    s_cbranch_vccnz L_lwe_205
    s_mov_b32 s80, 160000
L_lw_203:
    ds_read_b32 v24, v14 offset:96
    s_waitcnt lgkmcnt(0)
    v_cmp_le_i32 vcc, 8, v24
    s_sub_u32 s80, s80, 1
    s_cbranch_vccnz L_lwd_204
    s_cmp_lg_u32 s80, 0
    s_cbranch_scc1 L_lw_203
L_lwd_204:
    ds_read_b128 v[32:35], v26 offset:6784
    ds_read_b128 v[36:39], v26 offset:6800
    s_mov_b64 exec, s[84:85]
    ds_read_b128 v[128:131], v30 offset:2688
    ds_read_b128 v[132:135], v30 offset:3200
    ds_read_b128 v[136:139], v30 offset:3712
    ds_read_b128 v[140:143], v30 offset:4224
    s_mov_b64 exec, s[86:87]
    ds_read_b128 v[144:147], v30 offset:4736
    ds_read_b128 v[148:151], v30 offset:5248
    ds_read_b128 v[152:155], v30 offset:5760
    ds_read_b128 v[156:159], v30 offset:6272
    s_mov_b64 exec, -1
L_lwe_205:
    s_waitcnt lgkmcnt(8)
    v_max3_f32 v16, v32, v34, v36
    v_max_f32 v17, v16, v38
    s_nop 1
    v_max_f32_dpp v16, v17, v17 row_ror:8 row_mask:0xf bank_mask:0xf
    v_sub_f32 v32, v32, v16
    v_sub_f32 v34, v34, v16
    v_sub_f32 v36, v36, v16
    v_sub_f32 v38, v38, v16
    v_exp_f32 v32, v32
    v_exp_f32 v34, v34
    v_exp_f32 v36, v36
    v_exp_f32 v38, v38
    v_mul_f32 v18, v32, v33
    v_fmac_f32 v18, v34, v35
    v_fmac_f32 v18, v36, v37
    v_fmac_f32 v18, v38, v39
    s_cmp_lg_u32 s3, 7
    s_nop 0
    v_add_f32_dpp v17, v18, v18 row_ror:8 row_mask:0xf bank_mask:0xf
    s_cbranch_scc1 L_nolse_206
    v_log_f32 v18, v17
    s_mov_b64 exec, 0xff
    v_add_f32 v18, v16, v18
    v_bfi_b32 v18, v6, s4, v18
    buffer_store_dword v18, v10, s[52:55], s76 offen sc1
    s_mov_b64 exec, -1
L_nolse_206:
    s_waitcnt lgkmcnt(7)
    v_mfma_f32_16x16x32_bf16 v[64:67], v[96:99], v[128:131], 0
    s_waitcnt lgkmcnt(6)
    v_mfma_f32_16x16x32_bf16 v[68:71], v[100:103], v[132:135], 0
    s_waitcnt lgkmcnt(5)
    v_mfma_f32_16x16x32_bf16 v[72:75], v[104:107], v[136:139], 0
    s_waitcnt lgkmcnt(4)
    v_mfma_f32_16x16x32_bf16 v[76:79], v[108:111], v[140:143], 0
    s_waitcnt lgkmcnt(3)
    v_mfma_f32_16x16x32_bf16 v[64:67], v[112:115], v[144:147], v[64:67]
    v_rcp_f32 v18, v17
    s_waitcnt lgkmcnt(2)
    v_mfma_f32_16x16x32_bf16 v[68:71], v[116:119], v[148:151], v[68:71]
    s_waitcnt lgkmcnt(1)
    v_mfma_f32_16x16x32_bf16 v[72:75], v[120:123], v[152:155], v[72:75]
    s_waitcnt lgkmcnt(0)
    v_mfma_f32_16x16x32_bf16 v[76:79], v[124:127], v[156:159], v[76:79]
    s_nop 0
    v_mul_f32 v20, v32, v64
    v_mul_f32 v21, v32, v65
    v_mul_f32 v22, v32, v66
    v_mul_f32 v23, v32, v67
    v_fmac_f32 v20, v34, v68
    v_fmac_f32 v21, v34, v69
    v_fmac_f32 v22, v34, v70
    v_fmac_f32 v23, v34, v71
    v_fmac_f32 v20, v36, v72
    v_fmac_f32 v21, v36, v73
    v_fmac_f32 v22, v36, v74
    v_fmac_f32 v23, v36, v75
    v_fmac_f32 v20, v38, v76
    v_fmac_f32 v21, v38, v77
    v_fmac_f32 v22, v38, v78
    v_fmac_f32 v23, v38, v79
    v_add_f32_dpp v40, v20, v20 row_ror:8 row_mask:0xf bank_mask:0xf
    v_add_f32_dpp v41, v21, v21 row_ror:8 row_mask:0xf bank_mask:0xf
    v_add_f32_dpp v42, v22, v22 row_ror:8 row_mask:0xf bank_mask:0xf
    v_add_f32_dpp v43, v23, v23 row_ror:8 row_mask:0xf bank_mask:0xf
    v_mul_f32 v40, v40, v18
    v_mul_f32 v41, v41, v18
    v_mul_f32 v42, v42, v18
    v_mul_f32 v43, v43, v18
    v_bfi_b32 v40, v6, s4, v40
    v_bfi_b32 v41, v6, s4, v41
    v_bfi_b32 v42, v6, s4, v42
    v_bfi_b32 v43, v6, s4, v43
    s_mov_b64 exec, s[84:85]
    buffer_store_dwordx4 v[40:43], v10, s[52:55], s75 offen sc1
    s_mov_b64 exec, 1
    ds_add_u32 v14, v15 offset:100
    s_mov_b64 exec, -1
    v_add_u32 v16, v13, v14
    s_mov_b64 exec, 0xf
    ds_add_u32 v16, v15 offset:52
    s_mov_b64 exec, -1
    v_add_u32 v16, v13, v14
    s_mov_b64 exec, 0xf
    ds_add_u32 v16, v15 offset:4
    s_mov_b64 exec, -1
    s_mov_b32 s68, s6
    s_cmp_lt_u32 s6, 14
    s_cbranch_scc1 L_P4
    s_lshl_b32 s68, s5, 1
    s_add_u32 s68, s68, s6
    s_sub_u32 s68, s68, 14
    v_lshlrev_b32 v8, 11, v4
    v_lshl_add_u32 v8, v5, 6, v8
    v_lshl_add_u32 v8, v2, 3, v8
    s_lshl_b32 s67, s3, 7
    buffer_load_dwordx2 v[24:25], v8, s[40:43], s67 offen offset:0
    buffer_load_dwordx2 v[26:27], v8, s[40:43], s67 offen offset:32
    buffer_load_dwordx2 v[28:29], v8, s[40:43], s67 offen offset:1024
    buffer_load_dwordx2 v[30:31], v8, s[40:43], s67 offen offset:1056
    s_waitcnt vmcnt(0)
    v_lshlrev_b32 v32, 16, v24
    v_and_b32 v33, 0xffff0000, v24
    v_lshlrev_b32 v34, 16, v25
    v_and_b32 v35, 0xffff0000, v25
    v_lshlrev_b32 v36, 16, v26
    v_and_b32 v37, 0xffff0000, v26
    v_lshlrev_b32 v38, 16, v27
    v_and_b32 v39, 0xffff0000, v27
    v_mul_f32 v40, 0xbfb8aa3b, v32
    v_mul_f32 v41, 0xbfb8aa3b, v33
    v_mul_f32 v42, 0xbfb8aa3b, v34
    v_mul_f32 v43, 0xbfb8aa3b, v35
    v_mul_f32 v44, 0xbfb8aa3b, v36
    v_mul_f32 v45, 0xbfb8aa3b, v37
    v_mul_f32 v46, 0xbfb8aa3b, v38
    v_mul_f32 v47, 0xbfb8aa3b, v39
    v_exp_f32 v40, v40
    v_exp_f32 v41, v41
    v_exp_f32 v42, v42
    v_exp_f32 v43, v43
    v_exp_f32 v44, v44
    v_exp_f32 v45, v45
    v_exp_f32 v46, v46
    v_exp_f32 v47, v47
    v_add_f32 v40, 1.0, v40
    v_add_f32 v41, 1.0, v41
    v_add_f32 v42, 1.0, v42
    v_add_f32 v43, 1.0, v43
    v_add_f32 v44, 1.0, v44
    v_add_f32 v45, 1.0, v45
    v_add_f32 v46, 1.0, v46
    v_add_f32 v47, 1.0, v47
    v_rcp_f32 v40, v40
    v_rcp_f32 v41, v41
    v_rcp_f32 v42, v42
    v_rcp_f32 v43, v43
    v_rcp_f32 v44, v44
    v_rcp_f32 v45, v45
    v_rcp_f32 v46, v46
    v_rcp_f32 v47, v47
    v_mul_f32 v32, v32, v40
    v_mul_f32 v33, v33, v41
    v_mul_f32 v34, v34, v42
    v_mul_f32 v35, v35, v43
    v_mul_f32 v36, v36, v44
    v_mul_f32 v37, v37, v45
    v_mul_f32 v38, v38, v46
    v_mul_f32 v39, v39, v47
    v_cvt_pk_bf16_f32 v48, v32, v33
    v_cvt_pk_bf16_f32 v49, v34, v35
    v_cvt_pk_bf16_f32 v50, v36, v37
    v_cvt_pk_bf16_f32 v51, v38, v39
    v_lshlrev_b32 v32, 16, v28
    v_and_b32 v33, 0xffff0000, v28
    v_lshlrev_b32 v34, 16, v29
    v_and_b32 v35, 0xffff0000, v29
    v_lshlrev_b32 v36, 16, v30
    v_and_b32 v37, 0xffff0000, v30
    v_lshlrev_b32 v38, 16, v31
    v_and_b32 v39, 0xffff0000, v31
    v_mul_f32 v40, 0xbfb8aa3b, v32
    v_mul_f32 v41, 0xbfb8aa3b, v33
    v_mul_f32 v42, 0xbfb8aa3b, v34
    v_mul_f32 v43, 0xbfb8aa3b, v35
    v_mul_f32 v44, 0xbfb8aa3b, v36
    v_mul_f32 v45, 0xbfb8aa3b, v37
    v_mul_f32 v46, 0xbfb8aa3b, v38
    v_mul_f32 v47, 0xbfb8aa3b, v39
    v_exp_f32 v40, v40
    v_exp_f32 v41, v41
    v_exp_f32 v42, v42
    v_exp_f32 v43, v43
    v_exp_f32 v44, v44
    v_exp_f32 v45, v45
    v_exp_f32 v46, v46
    v_exp_f32 v47, v47
    v_add_f32 v40, 1.0, v40
    v_add_f32 v41, 1.0, v41
    v_add_f32 v42, 1.0, v42
    v_add_f32 v43, 1.0, v43
    v_add_f32 v44, 1.0, v44
    v_add_f32 v45, 1.0, v45
    v_add_f32 v46, 1.0, v46
    v_add_f32 v47, 1.0, v47
    v_rcp_f32 v40, v40
    v_rcp_f32 v41, v41
    v_rcp_f32 v42, v42
    v_rcp_f32 v43, v43
    v_rcp_f32 v44, v44
    v_rcp_f32 v45, v45
    v_rcp_f32 v46, v46
    v_rcp_f32 v47, v47
    v_mul_f32 v32, v32, v40
    v_mul_f32 v33, v33, v41
    v_mul_f32 v34, v34, v42
    v_mul_f32 v35, v35, v43
    v_mul_f32 v36, v36, v44
    v_mul_f32 v37, v37, v45
    v_mul_f32 v38, v38, v46
    v_mul_f32 v39, v39, v47
    v_cvt_pk_bf16_f32 v56, v32, v33
    v_cvt_pk_bf16_f32 v57, v34, v35
    v_cvt_pk_bf16_f32 v58, v36, v37
    v_cvt_pk_bf16_f32 v59, v38, v39
    s_add_u32 s78, s3, 4
    s_add_u32 s79, s78, 1
    s_and_b32 s78, s78, 15
    s_lshl_b32 s78, s78, 13
    v_mul_u32_u24 v16, 272, v4
    v_lshl_add_u32 v16, v2, 4, v16
    v_add_u32 v11, s78, v16
    s_mov_b32 s67, 32768
    s_mul_i32 s77, s3, 272
    s_add_u32 s67, s67, s77
    v_add_u32 v12, s67, v13
    s_add_u32 s78, s3, 20
    s_add_u32 s79, s78, 1
    s_and_b32 s78, s78, 15
    s_lshl_b32 s78, s78, 13
    v_add_u32 v164, s78, v160
    v_add_u32 v165, s78, v161
    v_add_u32 v166, s78, v162
    v_add_u32 v167, s78, v163
    s_mov_b32 s80, 160000
L_lw_207:
    ds_read_b32 v16, v14 offset:0
    s_waitcnt lgkmcnt(0)
    v_cmp_le_i32 vcc, s79, v16
    s_sub_u32 s80, s80, 1
    s_cbranch_vccnz L_lwd_208
    s_nop 15
    s_nop 15
    s_nop 15
    s_cmp_lg_u32 s80, 0
    s_cbranch_scc1 L_lw_207
L_lwd_208:
L_lwe_209:
    ds_read_b64_tr_b16 v[64:65], v164 offset:0
    ds_read_b64_tr_b16 v[66:67], v164 offset:2048
    ds_read_b64_tr_b16 v[68:69], v164 offset:4096
    ds_read_b64_tr_b16 v[70:71], v164 offset:6144
    ds_read_b64_tr_b16 v[72:73], v165 offset:0
    ds_read_b64_tr_b16 v[74:75], v165 offset:2048
    ds_read_b64_tr_b16 v[76:77], v165 offset:4096
    ds_read_b64_tr_b16 v[78:79], v165 offset:6144
    ds_read_b64_tr_b16 v[80:81], v166 offset:0
    ds_read_b64_tr_b16 v[82:83], v166 offset:2048
    ds_read_b64_tr_b16 v[84:85], v166 offset:4096
    ds_read_b64_tr_b16 v[86:87], v166 offset:6144
    ds_read_b64_tr_b16 v[88:89], v167 offset:0
    ds_read_b64_tr_b16 v[90:91], v167 offset:2048
    ds_read_b64_tr_b16 v[92:93], v167 offset:4096
    ds_read_b64_tr_b16 v[94:95], v167 offset:6144
    s_waitcnt lgkmcnt(0)
    s_add_u32 s78, s3, 28
    s_add_u32 s79, s78, 1
    s_and_b32 s78, s78, 15
    s_lshl_b32 s78, s78, 13
    v_add_u32 v164, s78, v160
    v_add_u32 v165, s78, v161
    v_add_u32 v166, s78, v162
    v_add_u32 v167, s78, v163
    s_mov_b32 s80, 160000
L_lw_210:
    ds_read_b32 v16, v14 offset:0
    s_waitcnt lgkmcnt(0)
    v_cmp_le_i32 vcc, s79, v16
    s_sub_u32 s80, s80, 1
    s_cbranch_vccnz L_lwd_211
    s_nop 15
    s_nop 15
    s_nop 15
    s_cmp_lg_u32 s80, 0
    s_cbranch_scc1 L_lw_210
L_lwd_211:
L_lwe_212:
    ds_read_b64_tr_b16 v[96:97], v164 offset:0
    ds_read_b64_tr_b16 v[98:99], v164 offset:2048
    ds_read_b64_tr_b16 v[100:101], v164 offset:4096
    ds_read_b64_tr_b16 v[102:103], v164 offset:6144
    ds_read_b64_tr_b16 v[104:105], v165 offset:0
    ds_read_b64_tr_b16 v[106:107], v165 offset:2048
    ds_read_b64_tr_b16 v[108:109], v165 offset:4096
    ds_read_b64_tr_b16 v[110:111], v165 offset:6144
    ds_read_b64_tr_b16 v[112:113], v166 offset:0
    ds_read_b64_tr_b16 v[114:115], v166 offset:2048
    ds_read_b64_tr_b16 v[116:117], v166 offset:4096
    ds_read_b64_tr_b16 v[118:119], v166 offset:6144
    ds_read_b64_tr_b16 v[120:121], v167 offset:0
    ds_read_b64_tr_b16 v[122:123], v167 offset:2048
    ds_read_b64_tr_b16 v[124:125], v167 offset:4096
    ds_read_b64_tr_b16 v[126:127], v167 offset:6144
    s_waitcnt lgkmcnt(0)
    v_mfma_f32_16x16x32_bf16 v[32:35], v[64:67], v[48:51], 0
    v_mov_b32_dpp v52, v48 row_ror:8 row_mask:0xf bank_mask:0xf
    v_mfma_f32_16x16x32_bf16 v[36:39], v[72:75], v[48:51], 0
    v_mov_b32_dpp v53, v49 row_ror:8 row_mask:0xf bank_mask:0xf
    v_mfma_f32_16x16x32_bf16 v[40:43], v[80:83], v[48:51], 0
    v_mov_b32_dpp v54, v50 row_ror:8 row_mask:0xf bank_mask:0xf
    v_mfma_f32_16x16x32_bf16 v[44:47], v[88:91], v[48:51], 0
    v_mov_b32_dpp v55, v51 row_ror:8 row_mask:0xf bank_mask:0xf
    v_mfma_f32_16x16x32_bf16 v[32:35], v[96:99], v[56:59], v[32:35]
    v_mov_b32_dpp v60, v56 row_ror:8 row_mask:0xf bank_mask:0xf
    v_mfma_f32_16x16x32_bf16 v[36:39], v[104:107], v[56:59], v[36:39]
    v_mov_b32_dpp v61, v57 row_ror:8 row_mask:0xf bank_mask:0xf
    v_mfma_f32_16x16x32_bf16 v[40:43], v[112:115], v[56:59], v[40:43]
    v_mov_b32_dpp v62, v58 row_ror:8 row_mask:0xf bank_mask:0xf
    v_mfma_f32_16x16x32_bf16 v[44:47], v[120:123], v[56:59], v[44:47]
    v_mov_b32_dpp v63, v59 row_ror:8 row_mask:0xf bank_mask:0xf
    v_mfma_f32_16x16x32_bf16 v[32:35], v[68:71], v[52:55], v[32:35]
    v_mfma_f32_16x16x32_bf16 v[36:39], v[76:79], v[52:55], v[36:39]
    v_mfma_f32_16x16x32_bf16 v[40:43], v[84:87], v[52:55], v[40:43]
    v_mfma_f32_16x16x32_bf16 v[44:47], v[92:95], v[52:55], v[44:47]
    v_mfma_f32_16x16x32_bf16 v[32:35], v[100:103], v[60:63], v[32:35]
    v_mfma_f32_16x16x32_bf16 v[36:39], v[108:111], v[60:63], v[36:39]
    v_mfma_f32_16x16x32_bf16 v[40:43], v[116:119], v[60:63], v[40:43]
    v_mfma_f32_16x16x32_bf16 v[44:47], v[124:127], v[60:63], v[44:47]
    s_mov_b64 exec, s[84:85]
    s_nop 3
    ds_write_b128 v11, v[32:35] offset:0
    ds_write_b128 v11, v[36:39] offset:64
    ds_write_b128 v11, v[40:43] offset:128
    ds_write_b128 v11, v[44:47] offset:192
    s_mov_b64 exec, 1
    ds_add_u32 v14, v15 offset:132
    s_mov_b64 exec, -1
L_nomm_213:
    ds_read_b32 v24, v14 offset:132
    ds_read2st64_b32 v[16:17], v12 offset0:0 offset1:32
    ds_read2st64_b32 v[18:19], v12 offset0:64 offset1:96
    ds_read2st64_b32 v[20:21], v12 offset0:128 offset1:160
    ds_read2st64_b32 v[22:23], v12 offset0:192 offset1:224
    s_waitcnt lgkmcnt(4)
    v_cmp_le_i32 vcc, 8, v24
    s_cbranch_vccnz L_lwe_216
    s_mov_b32 s80, 160000
L_lw_214:
    ds_read_b32 v24, v14 offset:132
    s_waitcnt lgkmcnt(0)
    v_cmp_le_i32 vcc, 8, v24
    s_sub_u32 s80, s80, 1
    s_cbranch_vccnz L_lwd_215
    s_nop 15
    s_nop 15
    s_nop 15
    s_cmp_lg_u32 s80, 0
    s_cbranch_scc1 L_lw_214
L_lwd_215:
    ds_read2st64_b32 v[16:17], v12 offset0:0 offset1:32
    ds_read2st64_b32 v[18:19], v12 offset0:64 offset1:96
    ds_read2st64_b32 v[20:21], v12 offset0:128 offset1:160
    ds_read2st64_b32 v[22:23], v12 offset0:192 offset1:224
L_lwe_216:
    s_waitcnt lgkmcnt(3)
    v_add_f32 v16, v16, v17
    s_waitcnt lgkmcnt(2)
    v_add_f32 v16, v16, v18
    v_add_f32 v16, v16, v19
    s_waitcnt lgkmcnt(1)
    v_add_f32 v16, v16, v20
    v_add_f32 v16, v16, v21
    s_waitcnt lgkmcnt(0)
    v_add_f32 v16, v16, v22
    v_add_f32 v16, v16, v23
    v_cvt_pk_bf16_f32 v16, v16, v16
    v_lshlrev_b32 v16, 16, v16
    v_mov_b32 v31, v16
    s_lshl_b32 s69, s68, 8
    s_lshl_b32 s67, s3, 12
    s_add_u32 s69, s69, s67
    s_add_u32 s67, s5, 1
    s_and_b32 s67, s67, 7
    s_lshl_b32 s67, s67, 15
    s_add_u32 s70, s69, s67
    s_add_u32 s70, s70, 2498560
    s_mov_b32 s80, 20007
L_poll_217:
    buffer_load_dword v30, v13, s[52:55], s70 offen sc1
    s_waitcnt vmcnt(0)
    v_xor_b32 v24, s4, v30
    v_and_b32 v24, v6, v24
    v_cmp_ne_u32 vcc, 0, v24
    s_sub_u32 s80, s80, 1
    s_cbranch_vccz L_pdone_218
    s_cmp_lg_u32 s80, 0
    s_cbranch_scc1 L_poll_217
L_pdone_218:
    v_and_b32 v30, 0xffff0000, v30
    s_add_u32 s70, s69, 2760704
    s_add_u32 s67, s5, 0
    s_and_b32 s67, s67, 7
    s_lshl_b32 s67, s67, 15
    s_add_u32 s71, s70, s67
    s_add_u32 s67, s5, 1
    s_and_b32 s67, s67, 7
    s_lshl_b32 s67, s67, 15
    s_add_u32 s73, s70, s67
    s_add_u32 s67, s5, 2
    s_and_b32 s67, s67, 7
    s_lshl_b32 s67, s67, 15
    s_add_u32 s74, s70, s67
    s_add_u32 s67, s5, 3
    s_and_b32 s67, s67, 7
    s_lshl_b32 s67, s67, 15
    s_add_u32 s75, s70, s67
    s_add_u32 s67, s5, 4
    s_and_b32 s67, s67, 7
    s_lshl_b32 s67, s67, 15
    s_add_u32 s76, s70, s67
    s_add_u32 s67, s5, 5
    s_and_b32 s67, s67, 7
    s_lshl_b32 s67, s67, 15
    s_add_u32 s77, s70, s67
    s_add_u32 s67, s5, 6
    s_and_b32 s67, s67, 7
    s_lshl_b32 s67, s67, 15
    s_add_u32 s78, s70, s67
    s_add_u32 s67, s5, 7
    s_and_b32 s67, s67, 7
    s_lshl_b32 s67, s67, 15
    s_add_u32 s79, s70, s67
    v_lshlrev_b32 v10, 1, v1
    s_lshr_b32 s69, s69, 1
    s_add_u32 s72, s71, 4194304
    s_mov_b32 s80, 20007
L_poll_219:
    buffer_load_dword v32, v13, s[52:55], s72 offen sc1
    buffer_load_dword v33, v13, s[52:55], s73 offen sc1
    buffer_load_dword v34, v13, s[52:55], s74 offen sc1
    buffer_load_dword v35, v13, s[52:55], s75 offen sc1
    buffer_load_dword v36, v13, s[52:55], s76 offen sc1
    buffer_load_dword v37, v13, s[52:55], s77 offen sc1
    buffer_load_dword v38, v13, s[52:55], s78 offen sc1
    buffer_load_dword v39, v13, s[52:55], s79 offen sc1
    s_waitcnt vmcnt(7)
    v_xor_b32 v24, s4, v32
    s_waitcnt vmcnt(6)
    v_bitop3_b32 v24, v33, v24, s4 bitop3:0xde
    s_waitcnt vmcnt(5)
    v_bitop3_b32 v24, v34, v24, s4 bitop3:0xde
    s_waitcnt vmcnt(4)
    v_bitop3_b32 v24, v35, v24, s4 bitop3:0xde
    s_waitcnt vmcnt(3)
    v_bitop3_b32 v24, v36, v24, s4 bitop3:0xde
    s_waitcnt vmcnt(2)
    v_bitop3_b32 v24, v37, v24, s4 bitop3:0xde
    s_waitcnt vmcnt(1)
    v_bitop3_b32 v24, v38, v24, s4 bitop3:0xde
    s_waitcnt vmcnt(0)
    v_bitop3_b32 v24, v39, v24, s4 bitop3:0xde
    v_and_b32 v24, v6, v24
    v_cmp_ne_u32 vcc, 0, v24
    s_sub_u32 s80, s80, 1
    s_cbranch_vccz L_pdone_220
    s_and_b32 s81, s80, 7
    s_cselect_b32 s81, 4194304, 0
    s_add_u32 s72, s71, s81
    s_cmp_lg_u32 s80, 0
    s_cbranch_scc1 L_poll_219
L_pdone_220:
    v_add_f32 v32, v32, v36
    v_add_f32 v33, v33, v37
    v_add_f32 v34, v34, v38
    v_add_f32 v35, v35, v39
    v_add_f32 v32, v32, v33
    v_add_f32 v34, v34, v35
    v_add_f32 v32, v32, v34
    v_cvt_pk_bf16_f32 v32, v32, v32
    v_lshlrev_b32 v32, 16, v32
    v_mul_f32 v32, v32, v31
    v_cvt_pk_bf16_f32 v32, v32, v32
    v_lshlrev_b32 v32, 16, v32
    v_add_f32 v32, v32, v30
    v_cvt_pk_bf16_f32 v32, v32, v32
    buffer_store_short v32, v10, s[48:51], s69 offen
    s_or_b32 s67, s68, s3
    s_cmp_lg_u32 s67, 0
    s_cbranch_scc1 L_nobump_221
    s_add_u32 s67, s64, 1
    v_mov_b32 v33, s67
    v_mov_b32 v34, 0
    s_mov_b64 exec, 1
    buffer_store_dword v33, v34, s[52:55], 0 offen
    s_mov_b64 exec, -1
L_nobump_221:
    s_branch L_done
L_P4:
    s_add_u32 s72, s5, 3
    s_and_b32 s72, s72, 7
    s_lshr_b32 s67, s6, 1
    s_add_u32 s72, s72, s67
    s_add_u32 s72, s72, 1
    s_cmp_ge_u32 s72, 7
    s_cselect_b32 s67, 7, 0
    s_sub_u32 s72, s72, s67
    s_cmp_ge_u32 s72, 7
    s_cselect_b32 s67, 7, 0
    s_sub_u32 s72, s72, s67
    s_mul_i32 s67, s5, 7
    s_add_u32 s72, s72, s67
    s_and_b32 s71, s68, 1
    s_mul_i32 s89, s5, 9
    s_add_u32 s89, s89, s72
    s_lshl1_add_u32 s89, s89, s71
    s_lshl_b32 s89, s89, 2
    s_add_u32 s89, s89, 3535872
    s_mul_i32 s70, s71, 114688
    s_lshl_b32 s67, s72, 11
    s_add_u32 s70, s70, s67
    s_lshl_b32 s67, s3, 8
    s_add_u32 s70, s70, s67
    s_add_u32 s70, s70, 3301376
    s_add_u32 s69, s70, 4194304
    v_lshrrev_b32 v8, 5, v1
    v_mul_u32_u24 v9, 4224, v8
    v_lshl_add_u32 v9, v3, 4, v9
    v_bfe_u32 v10, v1, 4, 1
    v_lshl_add_u32 v9, v10, 11, v9
    v_mul_u32_u24 v26, 4224, v1
    s_and_b32 s67, s68, 1
    s_lshl_b32 s67, s67, 11
    v_add_u32 v26, s67, v26
    s_add_u32 s78, s3, 4
    s_add_u32 s79, s78, 1
    s_and_b32 s78, s78, 15
    s_lshl_b32 s78, s78, 13
    v_mul_u32_u24 v16, 272, v4
    v_lshl_add_u32 v16, v2, 4, v16
    v_add_u32 v11, s78, v16
    s_mov_b32 s67, 32768
    v_bfe_u32 v16, v0, 2, 3
    v_mul_u32_u24 v16, 272, v16
    v_bfe_u32 v17, v0, 5, 1
    v_lshl_add_u32 v16, v17, 7, v16
    v_and_b32 v17, 3, v0
    v_lshl_add_u32 v16, v17, 2, v16
    v_bfe_u32 v17, v0, 6, 2
    v_lshl_add_u32 v16, v17, 4, v16
    v_bfe_u32 v17, v0, 8, 1
    v_lshl_add_u32 v16, v17, 6, v16
    v_add_u32 v12, s67, v16
    s_add_u32 s67, s78, 4096
    v_mul_u32_u24 v29, 272, v8
    v_bfe_u32 v30, v0, 3, 2
    v_lshl_add_u32 v29, v30, 6, v29
    v_and_b32 v30, 3, v0
    v_lshl_add_u32 v29, v30, 4, v29
    v_bfe_u32 v30, v0, 2, 1
    v_lshl_add_u32 v29, v30, 3, v29
    v_add_u32 v29, s67, v29
    v_mul_u32_u24 v30, 272, v4
    v_lshl_add_u32 v30, v5, 6, v30
    v_lshl_add_u32 v30, v2, 4, v30
    v_add_u32 v30, s67, v30
    s_add_u32 s78, s3, 20
    s_add_u32 s79, s78, 1
    s_and_b32 s78, s78, 15
    s_lshl_b32 s78, s78, 13
    v_add_u32 v164, s78, v160
    v_add_u32 v165, s78, v161
    v_add_u32 v166, s78, v162
    v_add_u32 v167, s78, v163
    s_mov_b32 s80, 160000
L_lw_222:
    ds_read_b32 v16, v14 offset:0
    s_waitcnt lgkmcnt(0)
    v_cmp_le_i32 vcc, s79, v16
    s_sub_u32 s80, s80, 1
    s_cbranch_vccnz L_lwd_223
    s_nop 15
    s_nop 15
    s_nop 15
    s_cmp_lg_u32 s80, 0
    s_cbranch_scc1 L_lw_222
L_lwd_223:
L_lwe_224:
    ds_read_b64_tr_b16 v[64:65], v164 offset:0
    ds_read_b64_tr_b16 v[66:67], v164 offset:2048
    ds_read_b64_tr_b16 v[68:69], v164 offset:4096
    ds_read_b64_tr_b16 v[70:71], v164 offset:6144
    ds_read_b64_tr_b16 v[72:73], v165 offset:0
    ds_read_b64_tr_b16 v[74:75], v165 offset:2048
    ds_read_b64_tr_b16 v[76:77], v165 offset:4096
    ds_read_b64_tr_b16 v[78:79], v165 offset:6144
    ds_read_b64_tr_b16 v[80:81], v166 offset:0
    ds_read_b64_tr_b16 v[82:83], v166 offset:2048
    ds_read_b64_tr_b16 v[84:85], v166 offset:4096
    ds_read_b64_tr_b16 v[86:87], v166 offset:6144
    ds_read_b64_tr_b16 v[88:89], v167 offset:0
    ds_read_b64_tr_b16 v[90:91], v167 offset:2048
    ds_read_b64_tr_b16 v[92:93], v167 offset:4096
    ds_read_b64_tr_b16 v[94:95], v167 offset:6144
    s_waitcnt lgkmcnt(0)
    s_add_u32 s78, s3, 28
    s_add_u32 s79, s78, 1
    s_and_b32 s78, s78, 15
    s_lshl_b32 s78, s78, 13
    v_add_u32 v164, s78, v160
    v_add_u32 v165, s78, v161
    v_add_u32 v166, s78, v162
    v_add_u32 v167, s78, v163
    s_mov_b32 s80, 160000
L_lw_225:
    ds_read_b32 v16, v14 offset:0
    s_waitcnt lgkmcnt(0)
    v_cmp_le_i32 vcc, s79, v16
    s_sub_u32 s80, s80, 1
    s_cbranch_vccnz L_lwd_226
    s_nop 15
    s_nop 15
    s_nop 15
    s_cmp_lg_u32 s80, 0
    s_cbranch_scc1 L_lw_225
L_lwd_226:
L_lwe_227:
    ds_read_b64_tr_b16 v[96:97], v164 offset:0
    ds_read_b64_tr_b16 v[98:99], v164 offset:2048
    ds_read_b64_tr_b16 v[100:101], v164 offset:4096
    ds_read_b64_tr_b16 v[102:103], v164 offset:6144
    ds_read_b64_tr_b16 v[104:105], v165 offset:0
    ds_read_b64_tr_b16 v[106:107], v165 offset:2048
    ds_read_b64_tr_b16 v[108:109], v165 offset:4096
    ds_read_b64_tr_b16 v[110:111], v165 offset:6144
    ds_read_b64_tr_b16 v[112:113], v166 offset:0
    ds_read_b64_tr_b16 v[114:115], v166 offset:2048
    ds_read_b64_tr_b16 v[116:117], v166 offset:4096
    ds_read_b64_tr_b16 v[118:119], v166 offset:6144
    ds_read_b64_tr_b16 v[120:121], v167 offset:0
    ds_read_b64_tr_b16 v[122:123], v167 offset:2048
    ds_read_b64_tr_b16 v[124:125], v167 offset:4096
    ds_read_b64_tr_b16 v[126:127], v167 offset:6144
    s_waitcnt lgkmcnt(0)
    s_mul_i32 s72, s5, 33792
    s_lshl_b32 s67, s3, 8
    s_add_u32 s72, s72, s67
    s_add_u32 s72, s72, 3022848
    s_add_u32 s73, s72, 8448
    s_add_u32 s74, s72, 16896
    s_add_u32 s75, s72, 25344
    s_mov_b32 exec_lo, 0x1
    s_mov_b32 exec_hi, 0x0
    s_add_u32 s76, s72, 4194304
    s_add_u32 s77, s73, 4194304
    s_add_u32 s78, s74, 4194304
    s_add_u32 s79, s75, 4194304
    s_mov_b32 s80, 20007
L_poll_228:
    buffer_load_dword v25, v26, s[52:55], s76 offen sc1
    s_waitcnt vmcnt(0)
    v_xor_b32 v24, s4, v25
    v_and_b32 v24, v6, v24
    v_cmp_ne_u32 vcc, 0, v24
    s_sub_u32 s80, s80, 1
    s_cbranch_vccz L_pdone_229
    s_and_b32 s81, s80, 7
    s_cselect_b32 s81, 4194304, 0
    s_add_u32 s76, s72, s81
    s_add_u32 s77, s73, s81
    s_add_u32 s78, s74, s81
    s_add_u32 s79, s75, s81
    s_cmp_lg_u32 s80, 0
    s_cbranch_scc1 L_poll_228
L_pdone_229:
    s_mov_b64 exec, -1
    s_mov_b32 s80, 20007
L_poll_230:
    buffer_load_dwordx4 v[32:35], v9, s[52:55], s76 offen sc1
    buffer_load_dwordx4 v[36:39], v9, s[52:55], s77 offen sc1
    buffer_load_dwordx4 v[40:43], v9, s[52:55], s78 offen sc1
    buffer_load_dwordx4 v[44:47], v9, s[52:55], s79 offen sc1
    s_waitcnt vmcnt(3)
    v_xor_b32 v24, s4, v32
    v_bitop3_b32 v24, v33, v24, s4 bitop3:0xde
    v_bitop3_b32 v24, v34, v24, s4 bitop3:0xde
    v_bitop3_b32 v24, v35, v24, s4 bitop3:0xde
    s_waitcnt vmcnt(2)
    v_bitop3_b32 v24, v36, v24, s4 bitop3:0xde
    v_bitop3_b32 v24, v37, v24, s4 bitop3:0xde
    v_bitop3_b32 v24, v38, v24, s4 bitop3:0xde
    v_bitop3_b32 v24, v39, v24, s4 bitop3:0xde
    s_waitcnt vmcnt(1)
    v_bitop3_b32 v24, v40, v24, s4 bitop3:0xde
    v_bitop3_b32 v24, v41, v24, s4 bitop3:0xde
    v_bitop3_b32 v24, v42, v24, s4 bitop3:0xde
    v_bitop3_b32 v24, v43, v24, s4 bitop3:0xde
    s_waitcnt vmcnt(0)
    v_bitop3_b32 v24, v44, v24, s4 bitop3:0xde
    v_bitop3_b32 v24, v45, v24, s4 bitop3:0xde
    v_bitop3_b32 v24, v46, v24, s4 bitop3:0xde
    v_bitop3_b32 v24, v47, v24, s4 bitop3:0xde
    v_and_b32 v24, v6, v24
    v_cmp_ne_u32 vcc, 0, v24
    s_sub_u32 s80, s80, 1
    s_cbranch_vccz L_pdone_231
    s_and_b32 s81, s80, 7
    s_cselect_b32 s81, 4194304, 0
    s_add_u32 s76, s72, s81
    s_add_u32 s77, s73, s81
    s_add_u32 s78, s74, s81
    s_add_u32 s79, s75, s81
    s_cmp_lg_u32 s80, 0
    s_cbranch_scc1 L_poll_230
L_pdone_231:
    v_perm_b32 v16, v33, v32, s7
    v_perm_b32 v17, v35, v34, s7
    v_perm_b32 v18, v37, v36, s7
    v_perm_b32 v19, v39, v38, s7
    v_perm_b32 v20, v41, v40, s7
    v_perm_b32 v21, v43, v42, s7
    v_perm_b32 v22, v45, v44, s7
    v_perm_b32 v23, v47, v46, s7
    ds_write_b64 v29, v[16:17] offset:0
    ds_write_b64 v29, v[18:19] offset:544
    ds_write_b64 v29, v[20:21] offset:1088
    ds_write_b64 v29, v[22:23] offset:1632
    ds_read_b128 v[48:51], v30 offset:0
    ds_read_b128 v[56:59], v30 offset:128
    s_waitcnt lgkmcnt(0)
    v_mfma_f32_16x16x32_bf16 v[32:35], v[64:67], v[48:51], 0
    v_mov_b32_dpp v52, v48 row_ror:8 row_mask:0xf bank_mask:0xf
    v_mfma_f32_16x16x32_bf16 v[36:39], v[72:75], v[48:51], 0
    v_mov_b32_dpp v53, v49 row_ror:8 row_mask:0xf bank_mask:0xf
    v_mfma_f32_16x16x32_bf16 v[40:43], v[80:83], v[48:51], 0
    v_mov_b32_dpp v54, v50 row_ror:8 row_mask:0xf bank_mask:0xf
    v_mfma_f32_16x16x32_bf16 v[44:47], v[88:91], v[48:51], 0
    v_mov_b32_dpp v55, v51 row_ror:8 row_mask:0xf bank_mask:0xf
    v_mfma_f32_16x16x32_bf16 v[32:35], v[96:99], v[56:59], v[32:35]
    v_mov_b32_dpp v60, v56 row_ror:8 row_mask:0xf bank_mask:0xf
    v_mfma_f32_16x16x32_bf16 v[36:39], v[104:107], v[56:59], v[36:39]
    v_mov_b32_dpp v61, v57 row_ror:8 row_mask:0xf bank_mask:0xf
    v_mfma_f32_16x16x32_bf16 v[40:43], v[112:115], v[56:59], v[40:43]
    v_mov_b32_dpp v62, v58 row_ror:8 row_mask:0xf bank_mask:0xf
    v_mfma_f32_16x16x32_bf16 v[44:47], v[120:123], v[56:59], v[44:47]
    v_mov_b32_dpp v63, v59 row_ror:8 row_mask:0xf bank_mask:0xf
    v_mfma_f32_16x16x32_bf16 v[32:35], v[68:71], v[52:55], v[32:35]
    v_mfma_f32_16x16x32_bf16 v[36:39], v[76:79], v[52:55], v[36:39]
    v_mfma_f32_16x16x32_bf16 v[40:43], v[84:87], v[52:55], v[40:43]
    v_mfma_f32_16x16x32_bf16 v[44:47], v[92:95], v[52:55], v[44:47]
    v_mfma_f32_16x16x32_bf16 v[32:35], v[100:103], v[60:63], v[32:35]
    v_mfma_f32_16x16x32_bf16 v[36:39], v[108:111], v[60:63], v[36:39]
    v_mfma_f32_16x16x32_bf16 v[40:43], v[116:119], v[60:63], v[40:43]
    v_mfma_f32_16x16x32_bf16 v[44:47], v[124:127], v[60:63], v[44:47]
    s_mov_b64 exec, s[84:85]
    s_nop 3
    ds_write_b128 v11, v[32:35] offset:0
    ds_write_b128 v11, v[36:39] offset:64
    ds_write_b128 v11, v[40:43] offset:128
    ds_write_b128 v11, v[44:47] offset:192
    s_mov_b64 exec, 1
    ds_add_u32 v14, v15 offset:124
    s_mov_b64 exec, -1
L_nomm_232:
    s_mov_b32 s80, 160000
L_lw_233:
    ds_read_b32 v24, v14 offset:124
    ds_read2st64_b32 v[16:17], v12 offset0:0 offset1:32
    ds_read2st64_b32 v[18:19], v12 offset0:64 offset1:96
    ds_read2st64_b32 v[20:21], v12 offset0:128 offset1:160
    ds_read2st64_b32 v[22:23], v12 offset0:192 offset1:224
    s_sub_u32 s80, s80, 1
    s_cbranch_scc1 L_lwe_235
    s_waitcnt lgkmcnt(4)
    v_cmp_le_i32 vcc, 8, v24
    s_cbranch_vccz L_lw_233
L_lwe_235:
    s_waitcnt lgkmcnt(3)
    v_add_f32 v16, v16, v17
    s_waitcnt lgkmcnt(2)
    v_add_f32 v16, v16, v18
    v_add_f32 v16, v16, v19
    s_waitcnt lgkmcnt(1)
    v_add_f32 v16, v16, v20
    v_add_f32 v16, v16, v21
    s_waitcnt lgkmcnt(0)
    v_add_f32 v16, v16, v22
    v_add_f32 v16, v16, v23
    v_cvt_pk_bf16_f32 v16, v16, v16
    v_lshlrev_b32 v16, 16, v16
    s_cmp_lg_u32 s71, 0
    s_cbranch_scc1 L_p4up_236
    v_mul_f32 v17, 0xbfb8aa3b, v16
    v_exp_f32 v17, v17
    s_nop 0
    v_add_f32 v17, 1.0, v17
    v_rcp_f32 v17, v17
    s_nop 0
    v_mul_f32 v16, v16, v17
    v_cvt_pk_bf16_f32 v16, v16, v16
    v_lshlrev_b32 v16, 16, v16
L_p4up_236:
    v_bfi_b32 v16, v6, s4, v16
    buffer_store_dword v16, v13, s[52:55], s69 offen
    buffer_store_dword v16, v13, s[52:55], s70 offen sc1
L_done:
L_exit:
    s_endpgm
.section .rodata,"a"
.p2align 6
.amdhsa_kernel adaLN_cond__sliding_block_cached__swiglu_ffn__decode_kernel
  .amdhsa_next_free_vgpr 168
  .amdhsa_next_free_sgpr 102
  .amdhsa_accum_offset 168
  .amdhsa_group_segment_fixed_size 0
  .amdhsa_kernarg_size 112
  .amdhsa_user_sgpr_count 2
  .amdhsa_user_sgpr_kernarg_segment_ptr 1
  .amdhsa_system_sgpr_workgroup_id_x 1
.end_amdhsa_kernel
```
